```python
import torch

def _softmax(x, axis=-1):
    return torch.softmax(x, dim=axis)
def _gelu(x):
    return torch.nn.functional.gelu(x, approximate="tanh")
def _silu(x):
    return torch.nn.functional.silu(x)
def _sigmoid(x):
    return torch.sigmoid(x)
def _layernorm(x, axis=-1, eps=1e-5):
    m = x.mean(dim=axis, keepdim=True)
    v = x.var(dim=axis, keepdim=True, unbiased=False)
    return (x - m) / torch.sqrt(v + eps)
def _scatter_add(tgt, idx, src, axis=0):
    return tgt.clone().index_add_(axis, idx, src)
def _segment_sum(src, seg, n):
    out = torch.zeros((n,) + src.shape[1:], dtype=src.dtype)
    return out.index_add_(0, seg, src)
def _pad(x, pw):
    flat = tuple(v for pair in reversed(pw) for v in pair)
    return torch.nn.functional.pad(x, flat)

kernel_name = 'gated_mix__ssm_conv_h3__glu_gated_reglu__prompt'

def setup_inputs():

    _w = (lambda a: (lambda t: t.to(torch.bfloat16) if t.is_floating_point() else t)(torch.as_tensor(a)))
    def _A_setup():
        B, S, D = 1, 2048, 512
        ks = 4
        return {
            "q": _w((lambda *s: torch.randn(*s, dtype=torch.bfloat16) * 0.05)(B, S, D)),
            "k": _w((lambda *s: torch.randn(*s, dtype=torch.bfloat16) * 0.05)(B, S, D)),
            "v": _w((lambda *s: torch.randn(*s, dtype=torch.bfloat16) * 0.05)(B, S, D)),
            "shift_k": _w((lambda *s: torch.randn(*s, dtype=torch.bfloat16) * 0.05)(D, ks) * 0.5),
            "ssm_k": _w((lambda *s: torch.randn(*s, dtype=torch.bfloat16) * 0.05)(D, S) * (1.0 / S ** 0.5)),
            "ssm_D": _w((lambda *s: torch.randn(*s, dtype=torch.bfloat16) * 0.05)(D)),
        }
    _A_in = _A_setup()

    def _B_setup():
        B, S, D, F = 1, 2048, 512, 1792
        return {
            "x": _w((lambda *s: torch.randn(*s, dtype=torch.bfloat16) * 0.05)(B, S, D)),
            "W_gate": _w((lambda *s: torch.randn(*s, dtype=torch.bfloat16) * 0.05)(D, F) * (2.0 / D) ** 0.5),
            "W_up": _w((lambda *s: torch.randn(*s, dtype=torch.bfloat16) * 0.05)(D, F) * (2.0 / D) ** 0.5),
            "W_down": _w((lambda *s: torch.randn(*s, dtype=torch.bfloat16) * 0.05)(F, D) * (1.0 / F) ** 0.5),
        }
    _B_in = _B_setup()

    return {
        "A_q": _A_in["q"],
        "A_k": _A_in["k"],
        "A_v": _A_in["v"],
        "A_shift_k": _A_in["shift_k"],
        "A_ssm_k": _A_in["ssm_k"],
        "A_ssm_D": _A_in["ssm_D"],
        "B_x": _B_in["x"],
        "B_W_gate": _B_in["W_gate"],
        "B_W_up": _B_in["W_up"],
        "B_W_down": _B_in["W_down"],
        "gate_w": _w((lambda *s: torch.randn(*s, dtype=torch.bfloat16) * 0.05)(512) * 16.0),
    }

def reference(A_q, A_k, A_v, A_shift_k, A_ssm_k, A_ssm_D, B_x, B_W_gate, B_W_up, B_W_down, gate_w):
    def _A_ref(q, k, v, shift_k, ssm_k, ssm_D):
        B, S, D = q.shape
        ks = shift_k.shape[-1]
        k_pad = _pad(k, ((0, 0), (ks - 1, 0), (0, 0)))
        k_shift = torch.zeros_like(k)
        for t in range(ks):
            k_shift = k_shift + k_pad[:, t:t + S, :] * shift_k[:, ks - 1 - t][None, None, :]
        kv = k_shift * v
        L = 2 * S
        kv_pad = _pad(kv, ((0, 0), (0, S), (0, 0)))
        kf_pad = _pad(ssm_k, ((0, 0), (0, S)))
        kv_f = (lambda x, axes=(-2,-1): torch.fft.rfft2(x.float(), dim=axes))(kv_pad[:, None, :, :], axes=(1, 2))
        kf_f = (lambda x, axes=(-2,-1): torch.fft.rfft2(x.float(), dim=axes))(kf_pad[:, None, :], axes=(1, 2))
        kf_f = (lambda x, *d: x.permute(*d))(kf_f, 1, 2, 0)
        y_f = kv_f * kf_f[None, :, :, :]
        y = (lambda x, s, axes=(-2,-1): torch.fft.irfft2(x, s=s, dim=axes).to(torch.bfloat16))(y_f, (1, L), axes=(1, 2))[:, 0, :S, :]
        y = y + kv * ssm_D[None, None, :]
        return q * y

    def _B_ref(x, W_gate, W_up, W_down):
        gate = torch.einsum("bsd,df->bsf", x, W_gate)
        up = torch.einsum("bsd,df->bsf", x, W_up)
        gate = gate * (lambda x, dt: x.to(dt))(gate > 0, gate.dtype)
        h = gate * up
        return torch.einsum("bsf,fd->bsd", h, W_down)

    x = A_q
    g = _sigmoid((x * gate_w).sum(-1, keepdims=True))
    a = _A_ref(x, A_k, A_v, A_shift_k, A_ssm_k, A_ssm_D)
    b = _B_ref(x, B_W_gate, B_W_up, B_W_down)
    return g * a + (1 - g) * b
```

```asm
; @launch grid=(256,1,1) block=(256,1,1) lds=163840
.amdgcn_target "amdgcn-amd-amdhsa--gfx950"
.text
.globl gated_mix__ssm_conv_h3__glu_gated_reglu__prompt_kernel
.p2align 8
.type gated_mix__ssm_conv_h3__glu_gated_reglu__prompt_kernel,@function
gated_mix__ssm_conv_h3__glu_gated_reglu__prompt_kernel:
    s_cmp_ge_u32 s2, 256
    s_cbranch_scc1 L_end
    s_load_dwordx16 s[56:71], s[0:1], 0
    s_load_dwordx8 s[72:79], s[0:1], 64
    s_load_dwordx4 s[80:83], s[0:1], 96
    v_lshrrev_b32 v1, 6, v0
    s_and_b32 s5, s2, 7
    v_readfirstlane_b32 s4, v1
    s_lshr_b32 s6, s2, 3
    v_and_b32 v0, 63, v0
    v_lshlrev_b32 v1, 4, v0
    s_and_b32 s54, s5, 1
    s_lshl_b32 s54, s54, 3
    s_and_b32 s3, s6, 7
    s_add_u32 s54, s54, s3
    s_lshr_b32 s55, s5, 1
    s_lshl_b32 s55, s55, 2
    s_lshr_b32 s3, s6, 3
    s_add_u32 s55, s55, s3
    s_and_b32 s84, s5, 6
    s_and_b32 s3, s5, 1
    s_lshl_b32 s3, s3, 2
    s_add_u32 s84, s84, s3
    s_and_b32 s84, s84, 7
    s_and_b32 s96, s55, 3
    s_and_b32 s97, s54, 7
    s_lshl_b32 s84, s84, 7
    s_add_u32 s85, s84, 128
    s_and_b32 s85, s85, 1023
    s_add_u32 s86, s85, 128
    s_and_b32 s86, s86, 1023
    s_lshl_b32 s90, s54, 17
    s_lshl_b32 s3, s4, 15
    s_add_u32 s90, s90, s3
    s_add_u32 s90, s90, 4096
    s_mul_i32 s91, s55, 224
    s_add_u32 s91, s91, 4096
    s_and_b32 s53, s4, 1
    v_lshrrev_b32 v200, 3, v0
    v_lshrrev_b32 v201, 4, v0
    v_and_b32 v202, 7, v0
    v_xor_b32 v201, v201, v202
    v_xor_b32 v202, 4, v201
    v_add_u32 v201, s97, v201
    v_add_u32 v202, s97, v202
    v_and_b32 v201, 7, v201
    v_and_b32 v202, 7, v202
    v_lshlrev_b32 v200, 10, v200
    v_lshl_add_u32 v201, v201, 4, v200
    v_lshl_add_u32 v202, v202, 4, v200
    s_add_u32 s3, s96, 0
    s_and_b32 s3, s3, 3
    s_lshl_b32 s3, s3, 13
    s_add_u32 s3, s3, s90
    s_sub_u32 s3, s3, 0
    v_add_u32 v134, s3, v201
    s_add_u32 s3, s96, 1
    s_and_b32 s3, s3, 3
    s_lshl_b32 s3, s3, 13
    s_add_u32 s3, s3, s90
    s_sub_u32 s3, s3, 1024
    v_add_u32 v135, s3, v202
    s_add_u32 s3, s96, 2
    s_and_b32 s3, s3, 3
    s_lshl_b32 s3, s3, 13
    s_add_u32 s3, s3, s90
    s_sub_u32 s3, s3, 2048
    v_add_u32 v136, s3, v201
    s_add_u32 s3, s96, 3
    s_and_b32 s3, s3, 3
    s_lshl_b32 s3, s3, 13
    s_add_u32 s3, s3, s90
    s_sub_u32 s3, s3, 3072
    v_add_u32 v137, s3, v202
    s_mov_b32 s90, 306783379
    s_lshl_b32 s7, s97, 3
    s_lshl_b32 s3, s53, 6
    v_add_u32 v200, s3, v0
    v_add_u32 v203, 0, v200
    v_mul_hi_u32 v204, v203, s90
    v_mul_u32_u24 v205, 14, v204
    v_sub_u32 v203, v203, v205
    v_add_u32 v204, s7, v204
    v_and_b32 v204, 63, v204
    v_mul_u32_u24 v204, 3584, v204
    v_lshl_add_u32 v203, v203, 4, v204
    v_add_u32 v138, s91, v203
    v_add_u32 v203, 128, v200
    v_mul_hi_u32 v204, v203, s90
    v_mul_u32_u24 v205, 14, v204
    v_sub_u32 v203, v203, v205
    v_add_u32 v204, s7, v204
    v_and_b32 v204, 63, v204
    v_mul_u32_u24 v204, 3584, v204
    v_lshl_add_u32 v203, v203, 4, v204
    v_add_u32 v139, s91, v203
    v_subrev_u32 v139, 2048, v139
    v_add_u32 v203, 256, v200
    v_mul_hi_u32 v204, v203, s90
    v_mul_u32_u24 v205, 14, v204
    v_sub_u32 v203, v203, v205
    v_add_u32 v204, s7, v204
    v_and_b32 v204, 63, v204
    v_mul_u32_u24 v204, 3584, v204
    v_lshl_add_u32 v203, v203, 4, v204
    v_add_u32 v140, s91, v203
    v_add_u32 v203, 384, v200
    v_mul_hi_u32 v204, v203, s90
    v_mul_u32_u24 v205, 14, v204
    v_sub_u32 v203, v203, v205
    v_add_u32 v204, s7, v204
    v_and_b32 v204, 63, v204
    v_mul_u32_u24 v204, 3584, v204
    v_lshl_add_u32 v203, v203, 4, v204
    v_add_u32 v141, s91, v203
    v_subrev_u32 v141, 2048, v141
    v_add_u32 v203, 512, v200
    v_mul_hi_u32 v204, v203, s90
    v_mul_u32_u24 v205, 14, v204
    v_sub_u32 v203, v203, v205
    v_add_u32 v204, s7, v204
    v_and_b32 v204, 63, v204
    v_mul_u32_u24 v204, 3584, v204
    v_lshl_add_u32 v203, v203, 4, v204
    v_add_u32 v142, s91, v203
    v_add_u32 v203, 640, v200
    v_mul_hi_u32 v204, v203, s90
    v_mul_u32_u24 v205, 14, v204
    v_sub_u32 v203, v203, v205
    v_add_u32 v204, s7, v204
    v_and_b32 v204, 63, v204
    v_mul_u32_u24 v204, 3584, v204
    v_lshl_add_u32 v203, v203, 4, v204
    v_add_u32 v143, s91, v203
    v_subrev_u32 v143, 2048, v143
    v_add_u32 v203, 768, v200
    v_mul_hi_u32 v204, v203, s90
    v_mul_u32_u24 v205, 14, v204
    v_sub_u32 v203, v203, v205
    v_add_u32 v204, s7, v204
    v_and_b32 v204, 63, v204
    v_mul_u32_u24 v204, 3584, v204
    v_lshl_add_u32 v203, v203, 4, v204
    v_add_u32 v144, s91, v203
    s_lshr_b32 s3, s4, 1
    s_mul_i32 s88, s3, 14464
    s_lshl_b32 s3, s53, 10
    s_add_u32 s88, s88, s3
    s_add_u32 s88, s88, 49152
    s_lshl_b32 s87, s4, 12
    s_waitcnt lgkmcnt(0)
    s_sub_u32 s8, s56, 4096
    s_subb_u32 s9, s57, 0
    s_mov_b32 s10, 2101248
    s_mov_b32 s11, 0x20000
    s_cmp_lt_u32 s4, 2
    s_cselect_b32 s28, s70, s72
    s_cselect_b32 s29, s71, s73
    s_sub_u32 s28, s28, 4096
    s_subb_u32 s29, s29, 0
    s_mov_b32 s30, 1839104
    s_mov_b32 s31, 0x20000
    s_add_u32 m0, s87, 0
    s_nop 0
    buffer_load_dwordx4 v134, s[8:11], s84 offen offset:0 lds
    s_mul_i32 s3, s84, 1792
    s_add_u32 m0, s88, 0
    s_nop 0
    buffer_load_dwordx4 v138, s[28:31], s3 offen offset:0 lds
    s_mov_b32 s12, s58
    s_mov_b32 s13, s59
    s_mov_b32 s14, 2097152
    s_mov_b32 s15, 0x20000
    s_mov_b32 s16, s60
    s_mov_b32 s17, s61
    s_mov_b32 s18, 2097152
    s_mov_b32 s19, 0x20000
    s_mov_b32 s20, s62
    s_mov_b32 s21, s63
    s_mov_b32 s22, 4096
    s_mov_b32 s23, 0x20000
    v_lshrrev_b32 v200, 3, v0
    v_and_b32 v201, 7, v0
    v_lshlrev_b32 v202, 10, v200
    v_lshl_add_u32 v202, v201, 4, v202
    s_lshl_b32 s3, s6, 16
    s_lshl_b32 s7, s5, 7
    s_add_u32 s3, s3, s7
    v_add_u32 v216, s3, v202
    v_lshrrev_b32 v202, 4, v0
    v_lshlrev_b32 v217, 11, v202
    v_bfe_u32 v203, v0, 2, 2
    v_lshl_add_u32 v217, v203, 7, v217
    v_and_b32 v203, 3, v0
    v_lshl_add_u32 v217, v203, 3, v217
    s_lshl_b32 s3, s4, 5
    s_add_u32 s3, s3, 135936
    v_add_u32 v217, s3, v217
    v_and_b32 v203, 15, v0
    s_lshl_b32 s3, s5, 9
    s_lshl_b32 s7, s4, 7
    s_add_u32 s3, s3, s7
    v_lshl_add_u32 v218, v203, 3, s3
    v_mul_u32_u24 v219, 144, v203
    v_lshl_add_u32 v219, v202, 5, v219
    s_mul_i32 s3, s4, 2304
    s_add_u32 s3, s3, 153344
    v_add_u32 v219, s3, v219
    v_mul_u32_u24 v220, 144, v200
    v_lshl_add_u32 v220, v201, 4, v220
    v_add_u32 v220, s3, v220
    v_lshlrev_b32 v221, 12, v200
    v_lshl_add_u32 v221, v201, 4, v221
    s_lshl_b32 s3, s5, 18
    s_lshl_b32 s7, s4, 16
    s_add_u32 s3, s3, s7
    s_lshl_b32 s7, s6, 7
    s_add_u32 s3, s3, s7
    s_add_u32 s3, s3, 0
    v_add_u32 v221, s3, v221
    s_lshl_b32 s90, s4, 11
    s_sub_u32 s90, s90, 8192
    v_add_u32 v7, s90, v216
    s_lshl_b32 s90, s4, 8
    s_add_u32 m0, s90, 135936
    s_mov_b64 exec, 0xffff
    buffer_load_dwordx4 v7, s[12:15], 0 offen lds
    s_mov_b64 exec, -1
    s_lshl_b32 s90, s4, 13
    s_add_u32 s91, s90, 32768
    s_lshl_b32 s101, s4, 10
    s_add_u32 m0, s101, 136960
    s_nop 0
    buffer_load_dwordx4 v216, s[12:15], s90 offen lds
    s_add_u32 m0, s101, 141056
    s_nop 0
    buffer_load_dwordx4 v216, s[12:15], s91 offen lds
    s_add_u32 m0, s101, 145152
    s_nop 0
    buffer_load_dwordx4 v216, s[16:19], s90 offen lds
    s_add_u32 m0, s101, 149248
    s_nop 0
    buffer_load_dwordx4 v216, s[16:19], s91 offen lds
    buffer_load_dwordx2 v[146:147], v218, s[20:23], 0 offen
    s_mov_b32 s48, s80
    s_mov_b32 s49, s81
    s_mov_b32 s50, 256
    s_mov_b32 s51, 0x20000
    s_memrealtime s[90:91]
    s_or_b32 s3, s2, s4
    s_cmp_eq_u32 s3, 0
    s_cselect_b32 s3, 0, 0x1000
    v_mov_b32 v6, s3
    s_waitcnt lgkmcnt(0)
    s_or_b32 s90, s90, 1
    v_mov_b32 v2, s90
    v_mov_b32 v3, s91
    s_mov_b64 exec, 1
    buffer_store_dwordx2 v[2:3], v6, s[48:51], 0 offen sc1
    s_mov_b64 exec, -1
    s_mov_b32 s24, s64
    s_mov_b32 s25, s65
    s_mov_b32 s26, 2097152
    s_mov_b32 s27, 0x20000
    s_mov_b32 s32, s74
    s_mov_b32 s33, s75
    s_mov_b32 s34, 1835008
    s_mov_b32 s35, 0x20000
    s_mov_b32 s36, s76
    s_mov_b32 s37, s77
    s_mov_b32 s38, 1024
    s_mov_b32 s39, 0x20000
    s_mov_b32 s40, s78
    s_mov_b32 s41, s79
    s_mov_b32 s42, 2097152
    s_mov_b32 s43, 0x20000
    s_mov_b32 s44, s82
    s_mov_b32 s45, s83
    s_mov_b32 s46, 16777216
    s_mov_b32 s47, 0x20000
    s_lshl_b32 s3, s5, 7
    s_lshl_b32 s7, s6, 2
    s_add_u32 s3, s3, s7
    s_and_b32 s7, s4, 2
    s_add_u32 s3, s3, s7
    v_mov_b32 v7, s3
    global_load_ushort v249, v7, s[66:67]
    s_lshl_b32 s3, s96, 3
    v_subrev_u32 v200, s3, v0
    v_and_b32 v200, 31, v200
    v_lshrrev_b32 v201, 5, v0
    v_bfe_u32 v202, v200, 1, 3
    v_xor_b32 v201, v201, v202
    v_lshlrev_b32 v200, 7, v200
    v_lshl_add_u32 v200, v201, 4, v200
    v_add_u32 v128, s87, v200
    v_xor_b32 v129, 32, v128
    v_xor_b32 v130, 64, v128
    v_xor_b32 v131, 96, v128
    v_bfe_u32 v200, v0, 4, 1
    v_mul_u32_u24 v200, 14464, v200
    v_lshrrev_b32 v201, 5, v0
    v_lshlrev_b32 v201, 3, v201
    v_bfe_u32 v202, v0, 2, 2
    v_add_u32 v201, v201, v202
    v_mul_u32_u24 v201, 224, v201
    v_and_b32 v202, 3, v0
    v_lshl_add_u32 v201, v202, 3, v201
    v_add_u32 v200, v200, v201
    v_add_u32 v132, 49152, v200
    v_add_u32 v133, 107008, v200
    s_lshl_b32 s3, s54, 2
    s_add_u32 s3, s3, s4
    s_mul_i32 s3, s3, 112
    s_mul_i32 s7, s55, 7
    s_add_u32 s3, s3, s7
    s_lshl_b32 s3, s3, 10
    s_add_u32 s89, s3, 4194304
    s_lshr_b32 s7, s4, 1
    s_mul_i32 s96, s7, 4608
    s_add_u32 s96, s96, 121344
    s_mul_i32 s97, s7, 16640
    s_add_u32 s97, s97, 130560
    s_lshl_b32 s98, s5, 6
    s_lshl_b32 s3, s6, 1
    s_add_u32 s98, s98, s3
    s_add_u32 s98, s98, s7
    s_lshl_b32 s98, s98, 12
    s_lshl_b32 s3, s53, 11
    s_add_u32 s98, s98, s3
    v_add_u32 v200, s96, v1
    v_subrev_u32 v201, 32, v0
    v_lshrrev_b32 v201, 1, v201
    v_mul_u32_u24 v201, 4160, v201
    v_and_b32 v202, 1, v0
    v_lshl_add_u32 v201, v202, 4, v201
    v_add_u32 v201, s97, v201
    v_cmp_gt_u32 vcc, 32, v0
    s_nop 1
    v_cndmask_b32 v226, v201, v200, vcc
    s_cmp_eq_u32 s53, 0
    s_cselect_b32 s3, s97, 107008
    v_mov_b32 v248, s3
    s_cselect_b64 vcc, -1, 0
    v_add_u32 v200, 107008, v1
    v_cndmask_b32 v226, v200, v226, vcc
    s_lshl_b32 s3, s53, 10
    s_add_u32 s3, s3, s97
    v_add_u32 v225, s3, v1
    v_and_b32 v200, 15, v0
    v_lshrrev_b32 v201, 4, v0
    v_add_u32 v202, 1, v200
    v_and_b32 v203, 3, v202
    v_mul_u32_u24 v222, 4160, v203
    v_and_b32 v202, 28, v202
    v_lshlrev_b32 v203, 3, v201
    v_sub_u32 v202, v202, v203
    v_add_u32 v202, 24, v202
    v_lshl_add_u32 v222, v202, 1, v222
    s_lshl_b32 s3, s53, 6
    s_add_u32 s7, s3, s97
    v_add_u32 v222, s7, v222
    v_lshl_add_u32 v223, v200, 1, v201
    v_lshlrev_b32 v223, 4, v223
    s_sub_u32 s7, s96, s3
    s_add_u32 s7, s7, 96
    v_add_u32 v223, s7, v223
    v_lshrrev_b32 v202, 1, v201
    v_lshl_add_u32 v202, v200, 1, v202
    v_lshlrev_b32 v224, 4, v202
    v_and_b32 v202, 1, v201
    v_lshlrev_b32 v202, 3, v202
    v_sub_u32 v224, v224, v202
    s_lshl_b32 s3, s53, 11
    s_add_u32 s7, s3, s96
    s_add_u32 s7, s7, 520
    v_add_u32 v224, s7, v224
    s_lshl_b32 s3, s4, 12
    s_add_u32 s7, s3, 90624
    v_add_u32 v227, s7, v1
    s_xor_b32 s7, s3, 4096
    s_add_u32 s7, s7, 90624
    v_add_u32 v228, s7, v1
    v_bfe_u32 v200, v0, 4, 1
    v_bfe_u32 v201, v0, 2, 2
    v_lshl_add_u32 v200, v200, 2, v201
    v_lshlrev_b32 v200, 7, v200
    v_lshrrev_b32 v201, 5, v0
    v_and_b32 v202, 3, v0
    v_lshl_add_u32 v201, v201, 2, v202
    v_lshl_add_u32 v200, v201, 4, v200
    s_add_u32 s3, s98, 2097152
    v_add_u32 v229, s3, v200
    s_add_u32 m0, s87, 16384
    s_nop 0
    buffer_load_dwordx4 v134, s[8:11], s85 offen offset:0 lds
    s_mul_i32 s3, s85, 1792
    s_add_u32 m0, s88, 28928
    s_nop 0
    buffer_load_dwordx4 v138, s[28:31], s3 offen offset:0 lds
    s_add_u32 m0, s87, 0
    s_nop 0
    buffer_load_dwordx4 v135, s[8:11], s84 offen offset:1024 lds
    buffer_load_dwordx4 v136, s[8:11], s84 offen offset:2048 lds
    buffer_load_dwordx4 v137, s[8:11], s84 offen offset:3072 lds
    s_mul_i32 s3, s84, 1792
    s_add_u32 m0, s88, 0
    s_nop 0
    buffer_load_dwordx4 v139, s[28:31], s3 offen offset:2048 lds
    s_add_u32 m0, s88, 4096
    s_nop 0
    buffer_load_dwordx4 v140, s[28:31], s3 offen offset:0 lds
    buffer_load_dwordx4 v141, s[28:31], s3 offen offset:2048 lds
    s_add_u32 m0, s88, 8192
    s_nop 0
    buffer_load_dwordx4 v142, s[28:31], s3 offen offset:0 lds
    buffer_load_dwordx4 v143, s[28:31], s3 offen offset:2048 lds
    s_add_u32 m0, s88, 12288
    s_nop 0
    buffer_load_dwordx4 v144, s[28:31], s3 offen offset:0 lds
    s_waitcnt vmcnt(13)
    s_barrier
    ds_read_b64_tr_b16 v[148:149], v217 offset:512
    ds_read_b64_tr_b16 v[150:151], v217 offset:1024
    ds_read_b64_tr_b16 v[152:153], v217 offset:1536
    ds_read_b64_tr_b16 v[154:155], v217 offset:2048
    ds_read_b64_tr_b16 v[156:157], v217 offset:2560
    ds_read_b64_tr_b16 v[158:159], v217 offset:9216
    ds_read_b64_tr_b16 v[160:161], v217 offset:9728
    ds_read_b64_tr_b16 v[162:163], v217 offset:10240
    ds_read_b64_tr_b16 v[164:165], v217 offset:10752
    v_alignbit_b32 v146, v146, v146, 16
    v_alignbit_b32 v147, v147, v147, 16
    s_waitcnt lgkmcnt(8)
    v_alignbit_b32 v166, v149, v148, 16
    s_waitcnt lgkmcnt(7)
    v_alignbit_b32 v167, v150, v149, 16
    v_alignbit_b32 v168, v151, v150, 16
    s_waitcnt lgkmcnt(6)
    v_alignbit_b32 v169, v152, v151, 16
    v_alignbit_b32 v170, v153, v152, 16
    s_waitcnt lgkmcnt(5)
    v_alignbit_b32 v171, v154, v153, 16
    v_alignbit_b32 v172, v155, v154, 16
    s_waitcnt lgkmcnt(4)
    v_alignbit_b32 v173, v156, v155, 16
    v_alignbit_b32 v174, v157, v156, 16
    v_dot2_f32_bf16 v176, v167, v146, 0
    s_add_u32 m0, s87, 32768
    s_nop 0
    buffer_load_dwordx4 v134, s[8:11], s86 offen offset:0 lds
    v_dot2_f32_bf16 v177, v150, v146, 0
    v_dot2_f32_bf16 v178, v168, v146, 0
    v_dot2_f32_bf16 v179, v151, v146, 0
    v_dot2_f32_bf16 v180, v169, v146, 0
    v_dot2_f32_bf16 v181, v152, v146, 0
    v_dot2_f32_bf16 v182, v170, v146, 0
    v_dot2_f32_bf16 v183, v153, v146, 0
    v_dot2_f32_bf16 v184, v171, v146, 0
    v_dot2_f32_bf16 v185, v154, v146, 0
    v_dot2_f32_bf16 v186, v172, v146, 0
    v_dot2_f32_bf16 v187, v155, v146, 0
    v_dot2_f32_bf16 v188, v173, v146, 0
    s_mul_i32 s3, s86, 1792
    s_add_u32 m0, s88, 57856
    s_nop 0
    buffer_load_dwordx4 v138, s[28:31], s3 offen offset:0 lds
    v_dot2_f32_bf16 v189, v156, v146, 0
    v_dot2_f32_bf16 v190, v174, v146, 0
    v_dot2_f32_bf16 v191, v157, v146, 0
    v_dot2_f32_bf16 v176, v166, v147, v176
    v_dot2_f32_bf16 v177, v149, v147, v177
    v_dot2_f32_bf16 v178, v167, v147, v178
    v_dot2_f32_bf16 v179, v150, v147, v179
    v_dot2_f32_bf16 v180, v168, v147, v180
    v_dot2_f32_bf16 v181, v151, v147, v181
    v_dot2_f32_bf16 v182, v169, v147, v182
    v_dot2_f32_bf16 v183, v152, v147, v183
    v_dot2_f32_bf16 v184, v170, v147, v184
    s_add_u32 m0, s87, 16384
    s_nop 0
    buffer_load_dwordx4 v135, s[8:11], s85 offen offset:1024 lds
    v_dot2_f32_bf16 v185, v153, v147, v185
    v_dot2_f32_bf16 v186, v171, v147, v186
    v_dot2_f32_bf16 v187, v154, v147, v187
    v_dot2_f32_bf16 v188, v172, v147, v188
    v_dot2_f32_bf16 v189, v155, v147, v189
    v_dot2_f32_bf16 v190, v173, v147, v190
    v_dot2_f32_bf16 v191, v156, v147, v191
    s_waitcnt lgkmcnt(3)
    v_lshlrev_b32 v148, 16, v158
    v_and_b32 v158, 0xffff0000, v158
    v_mul_f32 v176, v176, v148
    v_mul_f32 v177, v177, v158
    v_lshlrev_b32 v149, 16, v159
    buffer_load_dwordx4 v136, s[8:11], s85 offen offset:2048 lds
    v_and_b32 v159, 0xffff0000, v159
    v_mul_f32 v178, v178, v149
    v_mul_f32 v179, v179, v159
    s_waitcnt lgkmcnt(2)
    v_lshlrev_b32 v148, 16, v160
    v_and_b32 v160, 0xffff0000, v160
    v_mul_f32 v180, v180, v148
    v_mul_f32 v181, v181, v160
    v_lshlrev_b32 v149, 16, v161
    v_and_b32 v161, 0xffff0000, v161
    v_mul_f32 v182, v182, v149
    v_mul_f32 v183, v183, v161
    s_waitcnt lgkmcnt(1)
    v_lshlrev_b32 v148, 16, v162
    buffer_load_dwordx4 v137, s[8:11], s85 offen offset:3072 lds
    v_and_b32 v162, 0xffff0000, v162
    v_mul_f32 v184, v184, v148
    v_mul_f32 v185, v185, v162
    v_lshlrev_b32 v149, 16, v163
    v_and_b32 v163, 0xffff0000, v163
    v_mul_f32 v186, v186, v149
    v_mul_f32 v187, v187, v163
    s_waitcnt lgkmcnt(0)
    v_lshlrev_b32 v148, 16, v164
    v_and_b32 v164, 0xffff0000, v164
    v_mul_f32 v188, v188, v148
    v_mul_f32 v189, v189, v164
    v_lshlrev_b32 v149, 16, v165
    s_mul_i32 s3, s85, 1792
    s_add_u32 m0, s88, 28928
    s_nop 0
    buffer_load_dwordx4 v139, s[28:31], s3 offen offset:2048 lds
    v_and_b32 v165, 0xffff0000, v165
    v_mul_f32 v190, v190, v149
    v_mul_f32 v191, v191, v165
    v_cvt_pk_bf16_f32 v166, v183, v182
    v_cvt_pk_bf16_f32 v167, v181, v180
    v_cvt_pk_bf16_f32 v168, v179, v178
    v_cvt_pk_bf16_f32 v169, v177, v176
    v_cvt_pk_bf16_f32 v170, v191, v190
    v_cvt_pk_bf16_f32 v171, v189, v188
    v_cvt_pk_bf16_f32 v172, v187, v186
    v_cvt_pk_bf16_f32 v173, v185, v184
    ds_write_b128 v219, v[166:169]
    ds_write_b128 v219, v[170:173] offset:16
    ds_read_b128 v[176:179], v220
    ds_read_b128 v[180:183], v220 offset:1152
    s_waitcnt vmcnt(6)
    s_barrier
    ds_read_b128 a[28:31], v128 offset:0
    ds_read_b64_tr_b16 a[0:1], v132 offset:0
    ds_read_b64_tr_b16 a[2:3], v132 offset:896
    ds_read_b64_tr_b16 a[4:5], v132 offset:32
    ds_read_b64_tr_b16 a[6:7], v132 offset:928
    ds_read_b64_tr_b16 a[8:9], v132 offset:64
    ds_read_b64_tr_b16 a[10:11], v132 offset:960
    ds_read_b64_tr_b16 a[12:13], v132 offset:96
    ds_read_b64_tr_b16 a[14:15], v132 offset:992
    ds_read_b64_tr_b16 a[16:17], v132 offset:128
    ds_read_b64_tr_b16 a[18:19], v132 offset:1024
    ds_read_b64_tr_b16 a[20:21], v132 offset:160
    ds_read_b64_tr_b16 a[22:23], v132 offset:1056
    ds_read_b64_tr_b16 a[24:25], v132 offset:192
    ds_read_b64_tr_b16 a[26:27], v132 offset:1088
    s_waitcnt lgkmcnt(8)
    v_mfma_f32_32x32x16_bf16 v[16:31], a[0:3], a[28:31], 0
    ds_read_b128 a[60:63], v129 offset:0
    ds_read_b64_tr_b16 a[32:33], v132 offset:3584
    ds_read_b64_tr_b16 a[34:35], v132 offset:4480
    s_mul_i32 s3, s85, 1792
    s_add_u32 m0, s88, 33024
    s_nop 0
    buffer_load_dwordx4 v140, s[28:31], s3 offen offset:0 lds
    v_mfma_f32_32x32x16_bf16 v[32:47], a[4:7], a[28:31], 0
    ds_read_b64_tr_b16 a[36:37], v132 offset:3616
    ds_read_b64_tr_b16 a[38:39], v132 offset:4512
    buffer_load_dwordx4 v141, s[28:31], s3 offen offset:2048 lds
    s_lshl_b32 s94, s5, 2
    s_and_b32 s52, s6, 3
    v_mfma_f32_32x32x16_bf16 v[48:63], a[8:11], a[28:31], 0
    ds_read_b64_tr_b16 a[40:41], v132 offset:3648
    ds_read_b64_tr_b16 a[42:43], v132 offset:4544
    s_add_u32 m0, s88, 37120
    s_nop 0
    buffer_load_dwordx4 v142, s[28:31], s3 offen offset:0 lds
    s_waitcnt lgkmcnt(7)
    v_mfma_f32_32x32x16_bf16 v[64:79], a[12:15], a[28:31], 0
    ds_read_b64_tr_b16 a[44:45], v132 offset:3680
    ds_read_b64_tr_b16 a[46:47], v132 offset:4576
    buffer_load_dwordx4 v143, s[28:31], s3 offen offset:2048 lds
    s_add_u32 s94, s94, s52
    s_lshr_b32 s95, s6, 2
    v_mfma_f32_32x32x16_bf16 v[80:95], a[16:19], a[28:31], 0
    ds_read_b64_tr_b16 a[48:49], v132 offset:3712
    ds_read_b64_tr_b16 a[50:51], v132 offset:4608
    s_add_u32 m0, s88, 41216
    s_nop 0
    buffer_load_dwordx4 v144, s[28:31], s3 offen offset:0 lds
    s_mul_i32 s100, s4, 458752
    v_mfma_f32_32x32x16_bf16 v[96:111], a[20:23], a[28:31], 0
    ds_read_b64_tr_b16 a[52:53], v132 offset:3744
    ds_read_b64_tr_b16 a[54:55], v132 offset:4640
    s_lshl_b32 s52, s95, 7
    s_add_u32 s100, s100, s52
    v_lshrrev_b32 v10, 3, v0
    v_mfma_f32_32x32x16_bf16 v[112:127], a[24:27], a[28:31], 0
    ds_read_b64_tr_b16 a[56:57], v132 offset:3776
    ds_read_b64_tr_b16 a[58:59], v132 offset:4672
    s_add_u32 m0, s87, 32768
    s_nop 0
    buffer_load_dwordx4 v135, s[8:11], s86 offen offset:1024 lds
    s_waitcnt lgkmcnt(8)
    v_mfma_f32_32x32x16_bf16 v[16:31], a[32:35], a[60:63], v[16:31]
    ds_read_b128 a[28:31], v130 offset:0
    ds_read_b64_tr_b16 a[0:1], v132 offset:7168
    ds_read_b64_tr_b16 a[2:3], v132 offset:8064
    buffer_load_dwordx4 v136, s[8:11], s86 offen offset:2048 lds
    v_lshlrev_b32 v10, 10, v10
    v_mfma_f32_32x32x16_bf16 v[32:47], a[36:39], a[60:63], v[32:47]
    ds_read_b64_tr_b16 a[4:5], v132 offset:7200
    ds_read_b64_tr_b16 a[6:7], v132 offset:8096
    buffer_load_dwordx4 v137, s[8:11], s86 offen offset:3072 lds
    v_bfe_u32 v11, v0, 4, 1
    v_lshlrev_b32 v11, 2, v11
    v_mfma_f32_32x32x16_bf16 v[48:63], a[40:43], a[60:63], v[48:63]
    ds_read_b64_tr_b16 a[8:9], v132 offset:7232
    ds_read_b64_tr_b16 a[10:11], v132 offset:8128
    s_mul_i32 s3, s86, 1792
    s_add_u32 m0, s88, 57856
    s_nop 0
    buffer_load_dwordx4 v139, s[28:31], s3 offen offset:2048 lds
    s_waitcnt lgkmcnt(7)
    v_mfma_f32_32x32x16_bf16 v[64:79], a[44:47], a[60:63], v[64:79]
    ds_read_b64_tr_b16 a[12:13], v132 offset:7264
    ds_read_b64_tr_b16 a[14:15], v132 offset:8160
    s_add_u32 m0, s88, 61952
    s_nop 0
    buffer_load_dwordx4 v140, s[28:31], s3 offen offset:0 lds
    v_and_b32 v12, 7, v0
    v_mfma_f32_32x32x16_bf16 v[80:95], a[48:51], a[60:63], v[80:95]
    ds_read_b64_tr_b16 a[16:17], v132 offset:7296
    ds_read_b64_tr_b16 a[18:19], v132 offset:8192
    buffer_load_dwordx4 v141, s[28:31], s3 offen offset:2048 lds
    v_xor_b32 v11, v11, v12
    v_lshl_add_u32 v10, v11, 4, v10
    v_mfma_f32_32x32x16_bf16 v[96:111], a[52:55], a[60:63], v[96:111]
    ds_read_b64_tr_b16 a[20:21], v132 offset:7328
    ds_read_b64_tr_b16 a[22:23], v132 offset:8224
    s_add_u32 m0, s88, 66048
    s_nop 0
    buffer_load_dwordx4 v142, s[28:31], s3 offen offset:0 lds
    v_add_u32 v230, s100, v10
    v_mfma_f32_32x32x16_bf16 v[112:127], a[56:59], a[60:63], v[112:127]
    ds_read_b64_tr_b16 a[24:25], v132 offset:7360
    ds_read_b64_tr_b16 a[26:27], v132 offset:8256
    buffer_load_dwordx4 v143, s[28:31], s3 offen offset:2048 lds
    v_add_u32 v231, 7168, v230
    s_waitcnt lgkmcnt(8)
    v_mfma_f32_32x32x16_bf16 v[16:31], a[0:3], a[28:31], v[16:31]
    ds_read_b128 a[60:63], v131 offset:0
    ds_read_b64_tr_b16 a[32:33], v132 offset:10752
    ds_read_b64_tr_b16 a[34:35], v132 offset:11648
    s_add_u32 m0, s88, 70144
    s_nop 0
    buffer_load_dwordx4 v144, s[28:31], s3 offen offset:0 lds
    v_mfma_f32_32x32x16_bf16 v[32:47], a[4:7], a[28:31], v[32:47]
    ds_read_b64_tr_b16 a[36:37], v132 offset:10784
    ds_read_b64_tr_b16 a[38:39], v132 offset:11680
    s_lshl_b32 s52, s94, 1
    s_add_u32 s100, s52, s53
    s_xor_b32 s7, s100, 1
    v_mfma_f32_32x32x16_bf16 v[48:63], a[8:11], a[28:31], v[48:63]
    ds_read_b64_tr_b16 a[40:41], v132 offset:10816
    ds_read_b64_tr_b16 a[42:43], v132 offset:11712
    s_mov_b32 s101, 32768
    buffer_store_dwordx4 v[176:179], v221, s[44:47], 0 offen sc1
    s_waitcnt lgkmcnt(7)
    v_mfma_f32_32x32x16_bf16 v[64:79], a[12:15], a[28:31], v[64:79]
    ds_read_b64_tr_b16 a[44:45], v132 offset:10848
    ds_read_b64_tr_b16 a[46:47], v132 offset:11744
    buffer_store_dwordx4 v[180:183], v221, s[44:47], s101 offen sc1
    s_mul_i32 s100, s100, 114688
    s_mul_i32 s7, s7, 114688
    v_mfma_f32_32x32x16_bf16 v[80:95], a[16:19], a[28:31], v[80:95]
    ds_read_b64_tr_b16 a[48:49], v132 offset:10880
    ds_read_b64_tr_b16 a[50:51], v132 offset:11776
    buffer_load_dwordx2 v[2:3], off, s[48:51], 0 sc1
    s_mul_i32 s52, s4, 28672
    s_add_u32 s52, s52, 4194304
    v_mfma_f32_32x32x16_bf16 v[96:111], a[20:23], a[28:31], v[96:111]
    ds_read_b64_tr_b16 a[52:53], v132 offset:10912
    ds_read_b64_tr_b16 a[54:55], v132 offset:11808
    s_add_u32 s100, s100, s52
    s_add_u32 s7, s7, s52
    v_add_u32 v236, s100, v1
    v_mfma_f32_32x32x16_bf16 v[112:127], a[24:27], a[28:31], v[112:127]
    ds_read_b64_tr_b16 a[56:57], v132 offset:10944
    ds_read_b64_tr_b16 a[58:59], v132 offset:11840
    v_add_u32 v237, s7, v1
    s_lshl_b32 s99, s4, 11
    s_waitcnt lgkmcnt(8)
    v_mfma_f32_32x32x16_bf16 v[16:31], a[32:35], a[60:63], v[16:31]
    s_waitcnt vmcnt(12)
    s_waitcnt lgkmcnt(0)
    s_barrier
    v_mfma_f32_32x32x16_bf16 v[32:47], a[36:39], a[60:63], v[32:47]
    ds_read_b128 a[28:31], v128 offset:16384
    ds_read_b64_tr_b16 a[0:1], v132 offset:28928
    ds_read_b64_tr_b16 a[2:3], v132 offset:29824
    s_add_u32 s84, s86, 128
    s_and_b32 s84, s84, 1023
    s_add_u32 m0, s87, 0
    s_nop 0
    buffer_load_dwordx4 v134, s[8:11], s84 offen offset:0 lds
    v_mfma_f32_32x32x16_bf16 v[48:63], a[40:43], a[60:63], v[48:63]
    ds_read_b64_tr_b16 a[4:5], v132 offset:28960
    ds_read_b64_tr_b16 a[6:7], v132 offset:29856
    ds_read_b64_tr_b16 a[8:9], v132 offset:28992
    s_mul_i32 s3, s84, 1792
    s_add_u32 m0, s88, 0
    s_nop 0
    buffer_load_dwordx4 v138, s[28:31], s3 offen offset:0 lds
    v_mfma_f32_32x32x16_bf16 v[64:79], a[44:47], a[60:63], v[64:79]
    ds_read_b64_tr_b16 a[10:11], v132 offset:29888
    ds_read_b64_tr_b16 a[12:13], v132 offset:29024
    ds_read_b64_tr_b16 a[14:15], v132 offset:29920
    s_lshl_b32 s90, s54, 2
    s_add_u32 s90, s90, s4
    s_lshl_b32 s90, s90, 4
    s_add_u32 s90, s90, s55
    s_lshl_b32 s90, s90, 11
    s_add_u32 s90, s90, 4096
    buffer_load_dwordx4 v[208:211], v1, s[36:39], 0 offen
    v_mfma_f32_32x32x16_bf16 v[80:95], a[48:51], a[60:63], v[80:95]
    ds_read_b64_tr_b16 a[16:17], v132 offset:29056
    ds_read_b64_tr_b16 a[18:19], v132 offset:29952
    buffer_load_dwordx4 v[200:203], v1, s[8:11], s90 offen
    v_lshrrev_b32 v10, 5, v0
    v_bfe_u32 v11, v0, 2, 2
    v_mfma_f32_32x32x16_bf16 v[96:111], a[52:55], a[60:63], v[96:111]
    ds_read_b64_tr_b16 a[20:21], v132 offset:29088
    ds_read_b64_tr_b16 a[22:23], v132 offset:29984
    buffer_load_dwordx4 v[204:207], v1, s[8:11], s90 offen offset:1024
    v_lshl_add_u32 v10, v10, 2, v11
    v_lshlrev_b32 v10, 7, v10
    v_mfma_f32_32x32x16_bf16 v[112:127], a[56:59], a[60:63], v[112:127]
    ds_read_b64_tr_b16 a[24:25], v132 offset:29120
    ds_read_b64_tr_b16 a[26:27], v132 offset:30016
    v_bfe_u32 v11, v0, 3, 1
    s_lshr_b32 s52, s4, 1
    s_waitcnt lgkmcnt(8)
    v_mfma_f32_32x32x16_bf16 v[16:31], a[0:3], a[28:31], v[16:31]
    ds_read_b128 a[60:63], v129 offset:16384
    ds_read_b64_tr_b16 a[32:33], v132 offset:32512
    ds_read_b64_tr_b16 a[34:35], v132 offset:33408
    v_xor_b32 v11, s52, v11
    v_lshl_add_u32 v10, v11, 6, v10
    v_mfma_f32_32x32x16_bf16 v[32:47], a[4:7], a[28:31], v[32:47]
    ds_read_b64_tr_b16 a[36:37], v132 offset:32544
    ds_read_b64_tr_b16 a[38:39], v132 offset:33440
    v_bfe_u32 v11, v0, 4, 1
    v_lshl_add_u32 v10, v11, 5, v10
    v_and_b32 v11, 3, v0
    v_mfma_f32_32x32x16_bf16 v[48:63], a[8:11], a[28:31], v[48:63]
    ds_read_b64_tr_b16 a[40:41], v132 offset:32576
    ds_read_b64_tr_b16 a[42:43], v132 offset:33472
    v_lshl_add_u32 v10, v11, 3, v10
    v_add_u32 v232, s99, v10
    s_waitcnt lgkmcnt(7)
    v_mfma_f32_32x32x16_bf16 v[64:79], a[12:15], a[28:31], v[64:79]
    ds_read_b64_tr_b16 a[44:45], v132 offset:32608
    ds_read_b64_tr_b16 a[46:47], v132 offset:33504
    v_xor_b32 v233, 64, v232
    v_add_u32 v234, 65536, v232
    v_add_u32 v235, 65536, v233
    v_mfma_f32_32x32x16_bf16 v[80:95], a[16:19], a[28:31], v[80:95]
    ds_read_b64_tr_b16 a[48:49], v132 offset:32640
    ds_read_b64_tr_b16 a[50:51], v132 offset:33536
    s_and_b32 s100, s6, 3
    s_add_u32 s7, s95, s5
    v_mfma_f32_32x32x16_bf16 v[96:111], a[20:23], a[28:31], v[96:111]
    ds_read_b64_tr_b16 a[52:53], v132 offset:32672
    ds_read_b64_tr_b16 a[54:55], v132 offset:33568
    s_cmp_ge_u32 s7, 7
    s_cselect_b32 s52, 7, 0
    s_sub_u32 s7, s7, s52
    v_mfma_f32_32x32x16_bf16 v[112:127], a[24:27], a[28:31], v[112:127]
    ds_read_b64_tr_b16 a[56:57], v132 offset:32704
    ds_read_b64_tr_b16 a[58:59], v132 offset:33600
    s_cmp_ge_u32 s7, 7
    s_cselect_b32 s52, 7, 0
    s_waitcnt lgkmcnt(8)
    v_mfma_f32_32x32x16_bf16 v[16:31], a[32:35], a[60:63], v[16:31]
    ds_read_b128 a[28:31], v130 offset:16384
    ds_read_b64_tr_b16 a[0:1], v132 offset:36096
    ds_read_b64_tr_b16 a[2:3], v132 offset:36992
    s_sub_u32 s7, s7, s52
    s_lshl_b32 s7, s7, 12
    v_mfma_f32_32x32x16_bf16 v[32:47], a[36:39], a[60:63], v[32:47]
    ds_read_b64_tr_b16 a[4:5], v132 offset:36128
    ds_read_b64_tr_b16 a[6:7], v132 offset:37024
    s_add_u32 s80, s100, 0
    s_and_b32 s80, s80, 3
    s_lshl_b32 s80, s80, 10
    v_mfma_f32_32x32x16_bf16 v[48:63], a[40:43], a[60:63], v[48:63]
    ds_read_b64_tr_b16 a[8:9], v132 offset:36160
    ds_read_b64_tr_b16 a[10:11], v132 offset:37056
    s_add_u32 s81, s100, 1
    s_and_b32 s81, s81, 3
    s_waitcnt lgkmcnt(7)
    v_mfma_f32_32x32x16_bf16 v[64:79], a[44:47], a[60:63], v[64:79]
    ds_read_b64_tr_b16 a[12:13], v132 offset:36192
    ds_read_b64_tr_b16 a[14:15], v132 offset:37088
    s_lshl_b32 s81, s81, 10
    s_add_u32 s82, s100, 2
    s_and_b32 s82, s82, 3
    v_mfma_f32_32x32x16_bf16 v[80:95], a[48:51], a[60:63], v[80:95]
    ds_read_b64_tr_b16 a[16:17], v132 offset:36224
    ds_read_b64_tr_b16 a[18:19], v132 offset:37120
    s_lshl_b32 s82, s82, 10
    s_add_u32 s83, s100, 3
    s_and_b32 s83, s83, 3
    v_mfma_f32_32x32x16_bf16 v[96:111], a[52:55], a[60:63], v[96:111]
    ds_read_b64_tr_b16 a[20:21], v132 offset:36256
    ds_read_b64_tr_b16 a[22:23], v132 offset:37152
    s_lshl_b32 s83, s83, 10
    s_add_u32 s56, s80, s7
    s_add_u32 s57, s81, s7
    v_mfma_f32_32x32x16_bf16 v[112:127], a[56:59], a[60:63], v[112:127]
    ds_read_b64_tr_b16 a[24:25], v132 offset:36288
    ds_read_b64_tr_b16 a[26:27], v132 offset:37184
    s_add_u32 s58, s82, s7
    s_add_u32 s59, s83, s7
    s_waitcnt lgkmcnt(8)
    v_mfma_f32_32x32x16_bf16 v[16:31], a[0:3], a[28:31], v[16:31]
    ds_read_b128 a[60:63], v131 offset:16384
    ds_read_b64_tr_b16 a[32:33], v132 offset:39680
    ds_read_b64_tr_b16 a[34:35], v132 offset:40576
    s_add_u32 s7, s7, 4096
    v_mfma_f32_32x32x16_bf16 v[32:47], a[4:7], a[28:31], v[32:47]
    ds_read_b64_tr_b16 a[36:37], v132 offset:39712
    ds_read_b64_tr_b16 a[38:39], v132 offset:40608
    s_cmp_eq_u32 s7, 28672
    s_cselect_b32 s7, 0, s7
    s_add_u32 s60, s80, s7
    v_mfma_f32_32x32x16_bf16 v[48:63], a[8:11], a[28:31], v[48:63]
    ds_read_b64_tr_b16 a[40:41], v132 offset:39744
    ds_read_b64_tr_b16 a[42:43], v132 offset:40640
    s_add_u32 m0, s87, 0
    s_nop 0
    buffer_load_dwordx4 v135, s[8:11], s84 offen offset:1024 lds
    s_waitcnt lgkmcnt(7)
    v_mfma_f32_32x32x16_bf16 v[64:79], a[12:15], a[28:31], v[64:79]
    ds_read_b64_tr_b16 a[44:45], v132 offset:39776
    ds_read_b64_tr_b16 a[46:47], v132 offset:40672
    s_add_u32 s61, s81, s7
    s_add_u32 s62, s82, s7
    s_add_u32 s63, s83, s7
    v_mfma_f32_32x32x16_bf16 v[80:95], a[16:19], a[28:31], v[80:95]
    ds_read_b64_tr_b16 a[48:49], v132 offset:39808
    ds_read_b64_tr_b16 a[50:51], v132 offset:40704
    buffer_load_dwordx4 v136, s[8:11], s84 offen offset:2048 lds
    s_add_u32 s7, s7, 4096
    v_mfma_f32_32x32x16_bf16 v[96:111], a[20:23], a[28:31], v[96:111]
    ds_read_b64_tr_b16 a[52:53], v132 offset:39840
    ds_read_b64_tr_b16 a[54:55], v132 offset:40736
    s_cmp_eq_u32 s7, 28672
    s_cselect_b32 s7, 0, s7
    s_add_u32 s64, s80, s7
    v_mfma_f32_32x32x16_bf16 v[112:127], a[24:27], a[28:31], v[112:127]
    ds_read_b64_tr_b16 a[56:57], v132 offset:39872
    ds_read_b64_tr_b16 a[58:59], v132 offset:40768
    s_add_u32 s65, s81, s7
    s_add_u32 s66, s82, s7
    s_waitcnt lgkmcnt(8)
    v_mfma_f32_32x32x16_bf16 v[16:31], a[32:35], a[60:63], v[16:31]
    s_waitcnt vmcnt(10)
    s_waitcnt lgkmcnt(0)
    s_barrier
    v_mfma_f32_32x32x16_bf16 v[32:47], a[36:39], a[60:63], v[32:47]
    ds_read_b128 a[28:31], v128 offset:32768
    ds_read_b64_tr_b16 a[0:1], v133 offset:0
    ds_read_b64_tr_b16 a[2:3], v133 offset:896
    s_add_u32 m0, s87, 0
    s_nop 0
    buffer_load_dwordx4 v137, s[8:11], s84 offen offset:3072 lds
    v_mfma_f32_32x32x16_bf16 v[48:63], a[40:43], a[60:63], v[48:63]
    ds_read_b64_tr_b16 a[4:5], v133 offset:32
    ds_read_b64_tr_b16 a[6:7], v133 offset:928
    ds_read_b64_tr_b16 a[8:9], v133 offset:64
    s_mul_i32 s3, s84, 1792
    s_add_u32 m0, s88, 0
    s_nop 0
    buffer_load_dwordx4 v139, s[28:31], s3 offen offset:2048 lds
    v_mfma_f32_32x32x16_bf16 v[64:79], a[44:47], a[60:63], v[64:79]
    ds_read_b64_tr_b16 a[10:11], v133 offset:960
    ds_read_b64_tr_b16 a[12:13], v133 offset:96
    ds_read_b64_tr_b16 a[14:15], v133 offset:992
    s_add_u32 s67, s83, s7
    s_add_u32 s7, s7, 4096
    v_mfma_f32_32x32x16_bf16 v[80:95], a[48:51], a[60:63], v[80:95]
    ds_read_b64_tr_b16 a[16:17], v133 offset:128
    ds_read_b64_tr_b16 a[18:19], v133 offset:1024
    s_add_u32 m0, s88, 4096
    s_nop 0
    buffer_load_dwordx4 v140, s[28:31], s3 offen offset:0 lds
    v_mfma_f32_32x32x16_bf16 v[96:111], a[52:55], a[60:63], v[96:111]
    ds_read_b64_tr_b16 a[20:21], v133 offset:160
    ds_read_b64_tr_b16 a[22:23], v133 offset:1056
    s_cmp_eq_u32 s7, 28672
    s_cselect_b32 s7, 0, s7
    s_add_u32 s68, s80, s7
    v_mfma_f32_32x32x16_bf16 v[112:127], a[56:59], a[60:63], v[112:127]
    ds_read_b64_tr_b16 a[24:25], v133 offset:192
    ds_read_b64_tr_b16 a[26:27], v133 offset:1088
    buffer_load_dwordx4 v141, s[28:31], s3 offen offset:2048 lds
    s_add_u32 s69, s81, s7
    s_waitcnt lgkmcnt(8)
    v_mfma_f32_32x32x16_bf16 v[16:31], a[0:3], a[28:31], v[16:31]
    ds_read_b128 a[60:63], v129 offset:32768
    ds_read_b64_tr_b16 a[32:33], v133 offset:3584
    ds_read_b64_tr_b16 a[34:35], v133 offset:4480
    s_add_u32 s70, s82, s7
    s_add_u32 s71, s83, s7
    v_mfma_f32_32x32x16_bf16 v[32:47], a[4:7], a[28:31], v[32:47]
    ds_read_b64_tr_b16 a[36:37], v133 offset:3616
    ds_read_b64_tr_b16 a[38:39], v133 offset:4512
    s_add_u32 m0, s88, 8192
    s_nop 0
    buffer_load_dwordx4 v142, s[28:31], s3 offen offset:0 lds
    s_add_u32 s7, s7, 4096
    v_mfma_f32_32x32x16_bf16 v[48:63], a[8:11], a[28:31], v[48:63]
    ds_read_b64_tr_b16 a[40:41], v133 offset:3648
    ds_read_b64_tr_b16 a[42:43], v133 offset:4544
    s_cmp_eq_u32 s7, 28672
    s_cselect_b32 s7, 0, s7
    s_waitcnt lgkmcnt(7)
    v_mfma_f32_32x32x16_bf16 v[64:79], a[12:15], a[28:31], v[64:79]
    ds_read_b64_tr_b16 a[44:45], v133 offset:3680
    ds_read_b64_tr_b16 a[46:47], v133 offset:4576
    buffer_load_dwordx4 v143, s[28:31], s3 offen offset:2048 lds
    s_add_u32 s72, s80, s7
    s_add_u32 s73, s81, s7
    v_mfma_f32_32x32x16_bf16 v[80:95], a[16:19], a[28:31], v[80:95]
    ds_read_b64_tr_b16 a[48:49], v133 offset:3712
    ds_read_b64_tr_b16 a[50:51], v133 offset:4608
    s_add_u32 s74, s82, s7
    s_add_u32 s75, s83, s7
    s_add_u32 s7, s7, 4096
    v_mfma_f32_32x32x16_bf16 v[96:111], a[20:23], a[28:31], v[96:111]
    ds_read_b64_tr_b16 a[52:53], v133 offset:3744
    ds_read_b64_tr_b16 a[54:55], v133 offset:4640
    s_add_u32 m0, s88, 12288
    s_nop 0
    buffer_load_dwordx4 v144, s[28:31], s3 offen offset:0 lds
    v_mfma_f32_32x32x16_bf16 v[112:127], a[24:27], a[28:31], v[112:127]
    ds_read_b64_tr_b16 a[56:57], v133 offset:3776
    ds_read_b64_tr_b16 a[58:59], v133 offset:4672
    s_cmp_eq_u32 s7, 28672
    s_cselect_b32 s7, 0, s7
    s_waitcnt lgkmcnt(8)
    v_mfma_f32_32x32x16_bf16 v[16:31], a[32:35], a[60:63], v[16:31]
    ds_read_b128 a[28:31], v130 offset:32768
    ds_read_b64_tr_b16 a[0:1], v133 offset:7168
    ds_read_b64_tr_b16 a[2:3], v133 offset:8064
    s_add_u32 s85, s84, 128
    s_and_b32 s85, s85, 1023
    s_add_u32 m0, s87, 16384
    s_nop 0
    buffer_load_dwordx4 v134, s[8:11], s85 offen offset:0 lds
    v_mfma_f32_32x32x16_bf16 v[32:47], a[36:39], a[60:63], v[32:47]
    ds_read_b64_tr_b16 a[4:5], v133 offset:7200
    ds_read_b64_tr_b16 a[6:7], v133 offset:8096
    s_mul_i32 s3, s85, 1792
    s_add_u32 m0, s88, 28928
    s_nop 0
    buffer_load_dwordx4 v138, s[28:31], s3 offen offset:0 lds
    v_mfma_f32_32x32x16_bf16 v[48:63], a[40:43], a[60:63], v[48:63]
    ds_read_b64_tr_b16 a[8:9], v133 offset:7232
    ds_read_b64_tr_b16 a[10:11], v133 offset:8128
    s_lshl_b32 s90, s53, 10
    s_sub_u32 s90, s98, s90
    buffer_load_dwordx4 v[154:157], v1, s[24:27], s90 offen offset:0
    s_waitcnt lgkmcnt(7)
    v_mfma_f32_32x32x16_bf16 v[64:79], a[44:47], a[60:63], v[64:79]
    ds_read_b64_tr_b16 a[12:13], v133 offset:7264
    ds_read_b64_tr_b16 a[14:15], v133 offset:8160
    buffer_load_dwordx2 v[158:159], v1, s[24:27], s90 offen offset:16
    s_waitcnt vmcnt(13)
    v_lshlrev_b32 v214, 16, v208
    v_mfma_f32_32x32x16_bf16 v[80:95], a[48:51], a[60:63], v[80:95]
    ds_read_b64_tr_b16 a[16:17], v133 offset:7296
    ds_read_b64_tr_b16 a[18:19], v133 offset:8192
    buffer_load_dwordx4 v[160:163], v1, s[24:27], s90 offen offset:2048
    v_and_b32 v208, 0xffff0000, v208
    v_lshlrev_b32 v215, 16, v200
    v_mfma_f32_32x32x16_bf16 v[96:111], a[52:55], a[60:63], v[96:111]
    ds_read_b64_tr_b16 a[20:21], v133 offset:7328
    ds_read_b64_tr_b16 a[22:23], v133 offset:8224
    buffer_load_dwordx2 v[164:165], v1, s[24:27], s90 offen offset:2064
    v_lshlrev_b32 v7, 16, v204
    v_and_b32 v200, 0xffff0000, v200
    v_mfma_f32_32x32x16_bf16 v[112:127], a[56:59], a[60:63], v[112:127]
    ds_read_b64_tr_b16 a[24:25], v133 offset:7360
    ds_read_b64_tr_b16 a[26:27], v133 offset:8256
    v_and_b32 v204, 0xffff0000, v204
    v_mul_f32 v212, v215, v214
    s_waitcnt lgkmcnt(8)
    v_mfma_f32_32x32x16_bf16 v[16:31], a[0:3], a[28:31], v[16:31]
    ds_read_b128 a[60:63], v131 offset:32768
    ds_read_b64_tr_b16 a[32:33], v133 offset:10752
    ds_read_b64_tr_b16 a[34:35], v133 offset:11648
    v_mul_f32 v213, v7, v214
    v_fmac_f32 v212, v200, v208
    v_mfma_f32_32x32x16_bf16 v[32:47], a[4:7], a[28:31], v[32:47]
    ds_read_b64_tr_b16 a[36:37], v133 offset:10784
    ds_read_b64_tr_b16 a[38:39], v133 offset:11680
    v_fmac_f32 v213, v204, v208
    v_lshlrev_b32 v214, 16, v209
    v_and_b32 v209, 0xffff0000, v209
    v_mfma_f32_32x32x16_bf16 v[48:63], a[8:11], a[28:31], v[48:63]
    ds_read_b64_tr_b16 a[40:41], v133 offset:10816
    ds_read_b64_tr_b16 a[42:43], v133 offset:11712
    s_add_u32 m0, s87, 16384
    s_nop 0
    buffer_load_dwordx4 v135, s[8:11], s85 offen offset:1024 lds
    s_waitcnt lgkmcnt(7)
    v_mfma_f32_32x32x16_bf16 v[64:79], a[12:15], a[28:31], v[64:79]
    ds_read_b64_tr_b16 a[44:45], v133 offset:10848
    ds_read_b64_tr_b16 a[46:47], v133 offset:11744
    v_lshlrev_b32 v215, 16, v201
    v_lshlrev_b32 v7, 16, v205
    v_and_b32 v201, 0xffff0000, v201
    v_mfma_f32_32x32x16_bf16 v[80:95], a[16:19], a[28:31], v[80:95]
    ds_read_b64_tr_b16 a[48:49], v133 offset:10880
    ds_read_b64_tr_b16 a[50:51], v133 offset:11776
    buffer_load_dwordx4 v136, s[8:11], s85 offen offset:2048 lds
    v_and_b32 v205, 0xffff0000, v205
    v_fmac_f32 v212, v215, v214
    v_mfma_f32_32x32x16_bf16 v[96:111], a[20:23], a[28:31], v[96:111]
    ds_read_b64_tr_b16 a[52:53], v133 offset:10912
    ds_read_b64_tr_b16 a[54:55], v133 offset:11808
    v_fmac_f32 v213, v7, v214
    v_fmac_f32 v212, v201, v209
    v_fmac_f32 v213, v205, v209
    v_mfma_f32_32x32x16_bf16 v[112:127], a[24:27], a[28:31], v[112:127]
    ds_read_b64_tr_b16 a[56:57], v133 offset:10944
    ds_read_b64_tr_b16 a[58:59], v133 offset:11840
    v_lshlrev_b32 v214, 16, v210
    v_and_b32 v210, 0xffff0000, v210
    s_waitcnt lgkmcnt(8)
    v_mfma_f32_32x32x16_bf16 v[16:31], a[32:35], a[60:63], v[16:31]
    s_waitcnt vmcnt(8)
    s_waitcnt lgkmcnt(0)
    s_barrier
    v_mfma_f32_32x32x16_bf16 v[32:47], a[36:39], a[60:63], v[32:47]
    ds_read_b128 a[28:31], v128 offset:0
    ds_read_b64_tr_b16 a[0:1], v132 offset:0
    ds_read_b64_tr_b16 a[2:3], v132 offset:896
    s_add_u32 m0, s87, 16384
    s_nop 0
    buffer_load_dwordx4 v137, s[8:11], s85 offen offset:3072 lds
    v_mfma_f32_32x32x16_bf16 v[48:63], a[40:43], a[60:63], v[48:63]
    ds_read_b64_tr_b16 a[4:5], v132 offset:32
    ds_read_b64_tr_b16 a[6:7], v132 offset:928
    ds_read_b64_tr_b16 a[8:9], v132 offset:64
    s_mul_i32 s3, s85, 1792
    s_add_u32 m0, s88, 28928
    s_nop 0
    buffer_load_dwordx4 v139, s[28:31], s3 offen offset:2048 lds
    v_mfma_f32_32x32x16_bf16 v[64:79], a[44:47], a[60:63], v[64:79]
    ds_read_b64_tr_b16 a[10:11], v132 offset:960
    ds_read_b64_tr_b16 a[12:13], v132 offset:96
    ds_read_b64_tr_b16 a[14:15], v132 offset:992
    v_lshlrev_b32 v215, 16, v202
    v_lshlrev_b32 v7, 16, v206
    v_mfma_f32_32x32x16_bf16 v[80:95], a[48:51], a[60:63], v[80:95]
    ds_read_b64_tr_b16 a[16:17], v132 offset:128
    ds_read_b64_tr_b16 a[18:19], v132 offset:1024
    s_add_u32 m0, s88, 33024
    s_nop 0
    buffer_load_dwordx4 v140, s[28:31], s3 offen offset:0 lds
    v_and_b32 v202, 0xffff0000, v202
    v_mfma_f32_32x32x16_bf16 v[96:111], a[52:55], a[60:63], v[96:111]
    ds_read_b64_tr_b16 a[20:21], v132 offset:160
    ds_read_b64_tr_b16 a[22:23], v132 offset:1056
    v_and_b32 v206, 0xffff0000, v206
    v_fmac_f32 v212, v215, v214
    v_fmac_f32 v213, v7, v214
    v_mfma_f32_32x32x16_bf16 v[112:127], a[56:59], a[60:63], v[112:127]
    ds_read_b64_tr_b16 a[24:25], v132 offset:192
    ds_read_b64_tr_b16 a[26:27], v132 offset:1088
    buffer_load_dwordx4 v141, s[28:31], s3 offen offset:2048 lds
    v_fmac_f32 v212, v202, v210
    s_waitcnt lgkmcnt(8)
    v_mfma_f32_32x32x16_bf16 v[16:31], a[0:3], a[28:31], v[16:31]
    ds_read_b128 a[60:63], v129 offset:0
    ds_read_b64_tr_b16 a[32:33], v132 offset:3584
    ds_read_b64_tr_b16 a[34:35], v132 offset:4480
    v_fmac_f32 v213, v206, v210
    v_lshlrev_b32 v214, 16, v211
    v_mfma_f32_32x32x16_bf16 v[32:47], a[4:7], a[28:31], v[32:47]
    ds_read_b64_tr_b16 a[36:37], v132 offset:3616
    ds_read_b64_tr_b16 a[38:39], v132 offset:4512
    s_add_u32 m0, s88, 37120
    s_nop 0
    buffer_load_dwordx4 v142, s[28:31], s3 offen offset:0 lds
    v_and_b32 v211, 0xffff0000, v211
    v_mfma_f32_32x32x16_bf16 v[48:63], a[8:11], a[28:31], v[48:63]
    ds_read_b64_tr_b16 a[40:41], v132 offset:3648
    ds_read_b64_tr_b16 a[42:43], v132 offset:4544
    v_lshlrev_b32 v215, 16, v203
    v_lshlrev_b32 v7, 16, v207
    s_waitcnt lgkmcnt(7)
    v_mfma_f32_32x32x16_bf16 v[64:79], a[12:15], a[28:31], v[64:79]
    ds_read_b64_tr_b16 a[44:45], v132 offset:3680
    ds_read_b64_tr_b16 a[46:47], v132 offset:4576
    buffer_load_dwordx4 v143, s[28:31], s3 offen offset:2048 lds
    v_and_b32 v203, 0xffff0000, v203
    v_and_b32 v207, 0xffff0000, v207
    v_mfma_f32_32x32x16_bf16 v[80:95], a[16:19], a[28:31], v[80:95]
    ds_read_b64_tr_b16 a[48:49], v132 offset:3712
    ds_read_b64_tr_b16 a[50:51], v132 offset:4608
    v_fmac_f32 v212, v215, v214
    v_fmac_f32 v213, v7, v214
    v_fmac_f32 v212, v203, v211
    v_mfma_f32_32x32x16_bf16 v[96:111], a[20:23], a[28:31], v[96:111]
    ds_read_b64_tr_b16 a[52:53], v132 offset:3744
    ds_read_b64_tr_b16 a[54:55], v132 offset:4640
    s_add_u32 m0, s88, 41216
    s_nop 0
    buffer_load_dwordx4 v144, s[28:31], s3 offen offset:0 lds
    v_fmac_f32 v213, v207, v211
    v_mfma_f32_32x32x16_bf16 v[112:127], a[24:27], a[28:31], v[112:127]
    ds_read_b64_tr_b16 a[56:57], v132 offset:3776
    ds_read_b64_tr_b16 a[58:59], v132 offset:4672
    v_add_f32_dpp v212, v212, v212 row_ror:8 row_mask:0xf bank_mask:0xf
    v_add_f32_dpp v213, v213, v213 row_ror:8 row_mask:0xf bank_mask:0xf
    s_waitcnt lgkmcnt(8)
    v_mfma_f32_32x32x16_bf16 v[16:31], a[32:35], a[60:63], v[16:31]
    ds_read_b128 a[28:31], v130 offset:0
    ds_read_b64_tr_b16 a[0:1], v132 offset:7168
    ds_read_b64_tr_b16 a[2:3], v132 offset:8064
    s_add_u32 s86, s85, 128
    s_and_b32 s86, s86, 1023
    s_add_u32 m0, s87, 32768
    s_nop 0
    buffer_load_dwordx4 v134, s[8:11], s86 offen offset:0 lds
    v_mfma_f32_32x32x16_bf16 v[32:47], a[36:39], a[60:63], v[32:47]
    ds_read_b64_tr_b16 a[4:5], v132 offset:7200
    ds_read_b64_tr_b16 a[6:7], v132 offset:8096
    v_add_f32_dpp v212, v212, v212 row_ror:4 row_mask:0xf bank_mask:0xf
    v_add_f32_dpp v213, v213, v213 row_ror:4 row_mask:0xf bank_mask:0xf
    s_add_u32 s76, s80, s7
    v_mfma_f32_32x32x16_bf16 v[48:63], a[40:43], a[60:63], v[48:63]
    ds_read_b64_tr_b16 a[8:9], v132 offset:7232
    ds_read_b64_tr_b16 a[10:11], v132 offset:8128
    s_mul_i32 s3, s86, 1792
    s_add_u32 m0, s88, 57856
    s_nop 0
    buffer_load_dwordx4 v138, s[28:31], s3 offen offset:0 lds
    s_waitcnt lgkmcnt(7)
    v_mfma_f32_32x32x16_bf16 v[64:79], a[44:47], a[60:63], v[64:79]
    ds_read_b64_tr_b16 a[12:13], v132 offset:7264
    ds_read_b64_tr_b16 a[14:15], v132 offset:8160
    v_add_f32_dpp v212, v212, v212 row_ror:2 row_mask:0xf bank_mask:0xf
    v_add_f32_dpp v213, v213, v213 row_ror:2 row_mask:0xf bank_mask:0xf
    s_add_u32 s77, s81, s7
    v_mfma_f32_32x32x16_bf16 v[80:95], a[48:51], a[60:63], v[80:95]
    ds_read_b64_tr_b16 a[16:17], v132 offset:7296
    ds_read_b64_tr_b16 a[18:19], v132 offset:8192
    v_cmp_eq_u64 vcc, 0, v[2:3]
    s_cbranch_vccz L_ok_nonce_1
    s_mov_b32 s1, 0
L_spin_nonce_2:
    s_sleep 1
    buffer_load_dwordx2 v[2:3], off, s[48:51], 0 sc1
    s_waitcnt vmcnt(0)
    v_cmp_eq_u64 vcc, 0, v[2:3]
    s_cbranch_vccz L_ok_nonce_1
    s_add_u32 s1, s1, 1
    s_cmp_lt_u32 s1, 0x10000
    s_cbranch_scc1 L_spin_nonce_2
L_ok_nonce_1:
    s_lshl_b32 s90, s5, 2
    s_add_u32 s90, s90, s4
    s_lshl_b32 s90, s90, 5
    s_add_u32 s90, s90, s6
    s_lshl_b32 s90, s90, 6
    s_add_u32 s90, s90, 13631488
    s_mov_b64 exec, 1
    buffer_store_dwordx2 v[2:3], off, s[44:47], s90 sc1
    s_mov_b64 exec, -1
    v_mfma_f32_32x32x16_bf16 v[96:111], a[52:55], a[60:63], v[96:111]
    ds_read_b64_tr_b16 a[20:21], v132 offset:7328
    ds_read_b64_tr_b16 a[22:23], v132 offset:8224
    v_add_f32_dpp v212, v212, v212 row_ror:1 row_mask:0xf bank_mask:0xf
    v_add_f32_dpp v213, v213, v213 row_ror:1 row_mask:0xf bank_mask:0xf
    s_add_u32 s78, s82, s7
    v_mfma_f32_32x32x16_bf16 v[112:127], a[56:59], a[60:63], v[112:127]
    ds_read_b64_tr_b16 a[24:25], v132 offset:7360
    ds_read_b64_tr_b16 a[26:27], v132 offset:8256
    v_permlane16_swap_b32 v212, v213
    v_add_f32 v212, v212, v213
    s_waitcnt lgkmcnt(8)
    v_mfma_f32_32x32x16_bf16 v[16:31], a[0:3], a[28:31], v[16:31]
    ds_read_b128 a[60:63], v131 offset:0
    ds_read_b64_tr_b16 a[32:33], v132 offset:10752
    ds_read_b64_tr_b16 a[34:35], v132 offset:11648
    v_mov_b32 v213, v212
    s_add_u32 s79, s83, s7
    v_mfma_f32_32x32x16_bf16 v[32:47], a[4:7], a[28:31], v[32:47]
    ds_read_b64_tr_b16 a[36:37], v132 offset:10784
    ds_read_b64_tr_b16 a[38:39], v132 offset:11680
    v_permlane32_swap_b32 v212, v213
    v_add_f32 v212, v212, v213
    v_cvt_pk_bf16_f32 v212, v212, v212
    v_mfma_f32_32x32x16_bf16 v[48:63], a[8:11], a[28:31], v[48:63]
    ds_read_b64_tr_b16 a[40:41], v132 offset:10816
    ds_read_b64_tr_b16 a[42:43], v132 offset:11712
    s_add_u32 m0, s87, 32768
    s_nop 0
    buffer_load_dwordx4 v135, s[8:11], s86 offen offset:1024 lds
    s_waitcnt lgkmcnt(7)
    v_mfma_f32_32x32x16_bf16 v[64:79], a[12:15], a[28:31], v[64:79]
    ds_read_b64_tr_b16 a[44:45], v132 offset:10848
    ds_read_b64_tr_b16 a[46:47], v132 offset:11744
    v_and_b32 v212, 0xffff0000, v212
    v_mul_f32 v212, 0xbfb8aa3b, v212
    v_exp_f32 v212, v212
    v_mfma_f32_32x32x16_bf16 v[80:95], a[16:19], a[28:31], v[80:95]
    ds_read_b64_tr_b16 a[48:49], v132 offset:10880
    ds_read_b64_tr_b16 a[50:51], v132 offset:11776
    buffer_load_dwordx4 v136, s[8:11], s86 offen offset:2048 lds
    v_add_f32 v212, 1.0, v212
    v_rcp_f32 v212, v212
    v_mfma_f32_32x32x16_bf16 v[96:111], a[20:23], a[28:31], v[96:111]
    ds_read_b64_tr_b16 a[52:53], v132 offset:10912
    ds_read_b64_tr_b16 a[54:55], v132 offset:11808
    v_cvt_pk_bf16_f32 v212, v212, v212
    v_and_b32 v200, 0xffff0000, v212
    v_sub_f32 v212, 1.0, v200
    v_mfma_f32_32x32x16_bf16 v[112:127], a[24:27], a[28:31], v[112:127]
    ds_read_b64_tr_b16 a[56:57], v132 offset:10944
    ds_read_b64_tr_b16 a[58:59], v132 offset:11840
    s_waitcnt vmcnt(14)
    v_mov_b32 v146, v155
    s_waitcnt lgkmcnt(8)
    v_mfma_f32_32x32x16_bf16 v[16:31], a[32:35], a[60:63], v[16:31]
    s_waitcnt vmcnt(5)
    s_waitcnt lgkmcnt(0)
    s_barrier
    v_mfma_f32_32x32x16_bf16 v[32:47], a[36:39], a[60:63], v[32:47]
    ds_read_b128 a[28:31], v128 offset:16384
    ds_read_b64_tr_b16 a[0:1], v132 offset:28928
    ds_read_b64_tr_b16 a[2:3], v132 offset:29824
    s_add_u32 m0, s87, 32768
    s_nop 0
    buffer_load_dwordx4 v137, s[8:11], s86 offen offset:3072 lds
    v_mfma_f32_32x32x16_bf16 v[48:63], a[40:43], a[60:63], v[48:63]
    ds_read_b64_tr_b16 a[4:5], v132 offset:28960
    ds_read_b64_tr_b16 a[6:7], v132 offset:29856
    ds_read_b64_tr_b16 a[8:9], v132 offset:28992
    s_mul_i32 s3, s86, 1792
    s_add_u32 m0, s88, 57856
    s_nop 0
    buffer_load_dwordx4 v139, s[28:31], s3 offen offset:2048 lds
    v_mfma_f32_32x32x16_bf16 v[64:79], a[44:47], a[60:63], v[64:79]
    ds_read_b64_tr_b16 a[10:11], v132 offset:29888
    ds_read_b64_tr_b16 a[12:13], v132 offset:29024
    ds_read_b64_tr_b16 a[14:15], v132 offset:29920
    v_mov_b32 v147, v156
    v_mov_b32 v148, v157
    v_mfma_f32_32x32x16_bf16 v[80:95], a[48:51], a[60:63], v[80:95]
    ds_read_b64_tr_b16 a[16:17], v132 offset:29056
    ds_read_b64_tr_b16 a[18:19], v132 offset:29952
    s_add_u32 m0, s88, 61952
    s_nop 0
    buffer_load_dwordx4 v140, s[28:31], s3 offen offset:0 lds
    v_mov_b32 v149, v158
    v_mfma_f32_32x32x16_bf16 v[96:111], a[52:55], a[60:63], v[96:111]
    ds_read_b64_tr_b16 a[20:21], v132 offset:29088
    ds_read_b64_tr_b16 a[22:23], v132 offset:29984
    ds_write_b128 v225, v[146:149] offset:8352
    v_cvt_pk_bf16_f32 v212, v212, v212
    v_and_b32 v201, 0xffff0000, v212
    v_mfma_f32_32x32x16_bf16 v[112:127], a[56:59], a[60:63], v[112:127]
    ds_read_b64_tr_b16 a[24:25], v132 offset:29120
    ds_read_b64_tr_b16 a[26:27], v132 offset:30016
    buffer_load_dwordx4 v141, s[28:31], s3 offen offset:2048 lds
    v_lshrrev_b32 v213, 1, v0
    s_waitcnt lgkmcnt(9)
    v_mfma_f32_32x32x16_bf16 v[16:31], a[0:3], a[28:31], v[16:31]
    ds_read_b128 a[60:63], v129 offset:16384
    ds_read_b64_tr_b16 a[32:33], v132 offset:32512
    ds_read_b64_tr_b16 a[34:35], v132 offset:33408
    s_add_u32 s7, s7, 4096
    v_mfma_f32_32x32x16_bf16 v[32:47], a[4:7], a[28:31], v[32:47]
    ds_read_b64_tr_b16 a[36:37], v132 offset:32544
    ds_read_b64_tr_b16 a[38:39], v132 offset:33440
    s_add_u32 m0, s88, 66048
    s_nop 0
    buffer_load_dwordx4 v142, s[28:31], s3 offen offset:0 lds
    v_mfma_f32_32x32x16_bf16 v[48:63], a[8:11], a[28:31], v[48:63]
    ds_read_b64_tr_b16 a[40:41], v132 offset:32576
    ds_read_b64_tr_b16 a[42:43], v132 offset:33472
    s_cmp_eq_u32 s7, 28672
    s_cselect_b32 s7, 0, s7
    s_waitcnt lgkmcnt(7)
    v_mfma_f32_32x32x16_bf16 v[64:79], a[12:15], a[28:31], v[64:79]
    ds_read_b64_tr_b16 a[44:45], v132 offset:32608
    ds_read_b64_tr_b16 a[46:47], v132 offset:33504
    buffer_load_dwordx4 v143, s[28:31], s3 offen offset:2048 lds
    s_add_u32 s80, s80, s7
    s_add_u32 s81, s81, s7
    v_mfma_f32_32x32x16_bf16 v[80:95], a[16:19], a[28:31], v[80:95]
    ds_read_b64_tr_b16 a[48:49], v132 offset:32640
    ds_read_b64_tr_b16 a[50:51], v132 offset:33536
    v_alignbit_b32 v150, v156, v155, 16
    v_alignbit_b32 v151, v157, v156, 16
    v_alignbit_b32 v152, v158, v157, 16
    v_mfma_f32_32x32x16_bf16 v[96:111], a[20:23], a[28:31], v[96:111]
    ds_read_b64_tr_b16 a[52:53], v132 offset:32672
    ds_read_b64_tr_b16 a[54:55], v132 offset:33568
    s_add_u32 m0, s88, 70144
    s_nop 0
    buffer_load_dwordx4 v144, s[28:31], s3 offen offset:0 lds
    v_alignbit_b32 v153, v159, v158, 16
    v_mfma_f32_32x32x16_bf16 v[112:127], a[24:27], a[28:31], v[112:127]
    ds_read_b64_tr_b16 a[56:57], v132 offset:32704
    ds_read_b64_tr_b16 a[58:59], v132 offset:33600
    ds_write_b128 v225, v[150:153] offset:12512
    s_add_u32 s82, s82, s7
    s_waitcnt lgkmcnt(9)
    v_mfma_f32_32x32x16_bf16 v[16:31], a[32:35], a[60:63], v[16:31]
    ds_read_b128 a[28:31], v130 offset:16384
    ds_read_b64_tr_b16 a[0:1], v132 offset:36096
    ds_read_b64_tr_b16 a[2:3], v132 offset:36992
    s_add_u32 s84, s86, 128
    s_and_b32 s84, s84, 1023
    s_add_u32 m0, s87, 0
    s_nop 0
    buffer_load_dwordx4 v134, s[8:11], s84 offen offset:0 lds
    v_mfma_f32_32x32x16_bf16 v[32:47], a[36:39], a[60:63], v[32:47]
    ds_read_b64_tr_b16 a[4:5], v132 offset:36128
    ds_read_b64_tr_b16 a[6:7], v132 offset:37024
    s_mul_i32 s3, s84, 1792
    s_add_u32 m0, s88, 0
    s_nop 0
    buffer_load_dwordx4 v138, s[28:31], s3 offen offset:0 lds
    v_mfma_f32_32x32x16_bf16 v[48:63], a[40:43], a[60:63], v[48:63]
    ds_read_b64_tr_b16 a[8:9], v132 offset:36160
    ds_read_b64_tr_b16 a[10:11], v132 offset:37056
    s_add_u32 s83, s83, s7
    s_waitcnt lgkmcnt(8)
    v_mfma_f32_32x32x16_bf16 v[64:79], a[44:47], a[60:63], v[64:79]
    ds_read_b64_tr_b16 a[12:13], v132 offset:36192
    ds_read_b64_tr_b16 a[14:15], v132 offset:37088
    s_lshl_b32 s90, s2, 2
    s_add_u32 s90, s90, s4
    s_mul_i32 s90, s90, 1792
    buffer_load_dwordx4 v[250:253], v1, s[32:35], s90 offen
    v_mfma_f32_32x32x16_bf16 v[80:95], a[48:51], a[60:63], v[80:95]
    ds_read_b64_tr_b16 a[16:17], v132 offset:36224
    ds_read_b64_tr_b16 a[18:19], v132 offset:37120
    buffer_load_dwordx4 v[250:253], v1, s[32:35], s90 offen offset:768
    v_mfma_f32_32x32x16_bf16 v[96:111], a[52:55], a[60:63], v[96:111]
    ds_read_b64_tr_b16 a[20:21], v132 offset:36256
    ds_read_b64_tr_b16 a[22:23], v132 offset:37152
    v_alignbit_b32 v146, v161, v160, 16
    v_alignbit_b32 v147, v162, v161, 16
    v_alignbit_b32 v148, v163, v162, 16
    v_mfma_f32_32x32x16_bf16 v[112:127], a[56:59], a[60:63], v[112:127]
    ds_read_b64_tr_b16 a[24:25], v132 offset:36288
    ds_read_b64_tr_b16 a[26:27], v132 offset:37184
    v_alignbit_b32 v149, v164, v163, 16
    ds_write_b128 v225, v[146:149] offset:6240
    s_waitcnt lgkmcnt(9)
    v_mfma_f32_32x32x16_bf16 v[16:31], a[0:3], a[28:31], v[16:31]
    ds_read_b128 a[60:63], v131 offset:16384
    ds_read_b64_tr_b16 a[32:33], v132 offset:39680
    ds_read_b64_tr_b16 a[34:35], v132 offset:40576
    v_mfma_f32_32x32x16_bf16 v[32:47], a[4:7], a[28:31], v[32:47]
    ds_read_b64_tr_b16 a[36:37], v132 offset:39712
    ds_read_b64_tr_b16 a[38:39], v132 offset:40608
    s_lshl_b32 s101, s54, 2
    s_add_u32 s101, s101, s4
    s_lshl_b32 s101, s101, 4
    s_add_u32 s101, s101, s55
    s_lshl_b32 s101, s101, 4
    s_add_u32 s101, s101, 12582912
    s_mov_b64 exec, 0x10001
    buffer_store_dwordx2 v[200:201], v213, s[44:47], s101 offen sc1
    s_mov_b64 exec, -1
    v_mfma_f32_32x32x16_bf16 v[48:63], a[8:11], a[28:31], v[48:63]
    ds_read_b64_tr_b16 a[40:41], v132 offset:39744
    ds_read_b64_tr_b16 a[42:43], v132 offset:40640
    s_add_u32 m0, s87, 0
    s_nop 0
    buffer_load_dwordx4 v135, s[8:11], s84 offen offset:1024 lds
    s_waitcnt lgkmcnt(8)
    v_mfma_f32_32x32x16_bf16 v[64:79], a[12:15], a[28:31], v[64:79]
    ds_read_b64_tr_b16 a[44:45], v132 offset:39776
    ds_read_b64_tr_b16 a[46:47], v132 offset:40672
    v_mfma_f32_32x32x16_bf16 v[80:95], a[16:19], a[28:31], v[80:95]
    ds_read_b64_tr_b16 a[48:49], v132 offset:39808
    ds_read_b64_tr_b16 a[50:51], v132 offset:40704
    buffer_load_dwordx4 v136, s[8:11], s84 offen offset:2048 lds
    v_mfma_f32_32x32x16_bf16 v[96:111], a[20:23], a[28:31], v[96:111]
    ds_read_b64_tr_b16 a[52:53], v132 offset:39840
    ds_read_b64_tr_b16 a[54:55], v132 offset:40736
    v_mov_b32 v150, v161
    v_mov_b32 v151, v162
    v_mov_b32 v152, v163
    v_mfma_f32_32x32x16_bf16 v[112:127], a[24:27], a[28:31], v[112:127]
    ds_read_b64_tr_b16 a[56:57], v132 offset:39872
    ds_read_b64_tr_b16 a[58:59], v132 offset:40768
    v_mov_b32 v153, v164
    ds_write_b128 v225, v[150:153] offset:10400
    s_waitcnt lgkmcnt(9)
    v_mfma_f32_32x32x16_bf16 v[16:31], a[32:35], a[60:63], v[16:31]
    s_waitcnt vmcnt(7)
    s_waitcnt lgkmcnt(0)
    s_barrier
    v_mfma_f32_32x32x16_bf16 v[32:47], a[36:39], a[60:63], v[32:47]
    ds_read_b128 a[28:31], v128 offset:32768
    ds_read_b64_tr_b16 a[0:1], v133 offset:0
    ds_read_b64_tr_b16 a[2:3], v133 offset:896
    s_add_u32 m0, s87, 0
    s_nop 0
    buffer_load_dwordx4 v137, s[8:11], s84 offen offset:3072 lds
    v_mfma_f32_32x32x16_bf16 v[48:63], a[40:43], a[60:63], v[48:63]
    ds_read_b64_tr_b16 a[4:5], v133 offset:32
    ds_read_b64_tr_b16 a[6:7], v133 offset:928
    ds_read_b64_tr_b16 a[8:9], v133 offset:64
    s_mul_i32 s3, s84, 1792
    s_add_u32 m0, s88, 0
    s_nop 0
    buffer_load_dwordx4 v139, s[28:31], s3 offen offset:2048 lds
    v_mfma_f32_32x32x16_bf16 v[64:79], a[44:47], a[60:63], v[64:79]
    ds_read_b64_tr_b16 a[10:11], v133 offset:960
    ds_read_b64_tr_b16 a[12:13], v133 offset:96
    ds_read_b64_tr_b16 a[14:15], v133 offset:992
    v_mfma_f32_32x32x16_bf16 v[80:95], a[48:51], a[60:63], v[80:95]
    ds_read_b64_tr_b16 a[16:17], v133 offset:128
    ds_read_b64_tr_b16 a[18:19], v133 offset:1024
    s_add_u32 m0, s88, 4096
    s_nop 0
    buffer_load_dwordx4 v140, s[28:31], s3 offen offset:0 lds
    v_mfma_f32_32x32x16_bf16 v[96:111], a[52:55], a[60:63], v[96:111]
    ds_read_b64_tr_b16 a[20:21], v133 offset:160
    ds_read_b64_tr_b16 a[22:23], v133 offset:1056
    v_alignbit_b32 v146, v162, v161, 16
    v_alignbit_b32 v147, v163, v162, 16
    v_alignbit_b32 v148, v164, v163, 16
    v_mfma_f32_32x32x16_bf16 v[112:127], a[56:59], a[60:63], v[112:127]
    ds_read_b64_tr_b16 a[24:25], v133 offset:192
    ds_read_b64_tr_b16 a[26:27], v133 offset:1088
    buffer_load_dwordx4 v141, s[28:31], s3 offen offset:2048 lds
    v_alignbit_b32 v149, v165, v164, 16
    s_waitcnt lgkmcnt(8)
    v_mfma_f32_32x32x16_bf16 v[16:31], a[0:3], a[28:31], v[16:31]
    ds_read_b128 a[60:63], v129 offset:32768
    ds_read_b64_tr_b16 a[32:33], v133 offset:3584
    ds_read_b64_tr_b16 a[34:35], v133 offset:4480
    ds_write_b128 v225, v[146:149] offset:14560
    v_mfma_f32_32x32x16_bf16 v[32:47], a[4:7], a[28:31], v[32:47]
    ds_read_b64_tr_b16 a[36:37], v133 offset:3616
    ds_read_b64_tr_b16 a[38:39], v133 offset:4512
    s_add_u32 m0, s88, 8192
    s_nop 0
    buffer_load_dwordx4 v142, s[28:31], s3 offen offset:0 lds
    v_mfma_f32_32x32x16_bf16 v[48:63], a[8:11], a[28:31], v[48:63]
    ds_read_b64_tr_b16 a[40:41], v133 offset:3648
    ds_read_b64_tr_b16 a[42:43], v133 offset:4544
    s_waitcnt lgkmcnt(8)
    v_mfma_f32_32x32x16_bf16 v[64:79], a[12:15], a[28:31], v[64:79]
    ds_read_b64_tr_b16 a[44:45], v133 offset:3680
    ds_read_b64_tr_b16 a[46:47], v133 offset:4576
    buffer_load_dwordx4 v143, s[28:31], s3 offen offset:2048 lds
    v_mfma_f32_32x32x16_bf16 v[80:95], a[16:19], a[28:31], v[80:95]
    ds_read_b64_tr_b16 a[48:49], v133 offset:3712
    ds_read_b64_tr_b16 a[50:51], v133 offset:4608
    v_mfma_f32_32x32x16_bf16 v[96:111], a[20:23], a[28:31], v[96:111]
    ds_read_b64_tr_b16 a[52:53], v133 offset:3744
    ds_read_b64_tr_b16 a[54:55], v133 offset:4640
    s_add_u32 m0, s88, 12288
    s_nop 0
    buffer_load_dwordx4 v144, s[28:31], s3 offen offset:0 lds
    v_mfma_f32_32x32x16_bf16 v[112:127], a[24:27], a[28:31], v[112:127]
    ds_read_b64_tr_b16 a[56:57], v133 offset:3776
    ds_read_b64_tr_b16 a[58:59], v133 offset:4672
    s_waitcnt lgkmcnt(8)
    v_mfma_f32_32x32x16_bf16 v[16:31], a[32:35], a[60:63], v[16:31]
    ds_read_b128 a[28:31], v130 offset:32768
    ds_read_b64_tr_b16 a[0:1], v133 offset:7168
    ds_read_b64_tr_b16 a[2:3], v133 offset:8064
    s_add_u32 s85, s84, 128
    s_and_b32 s85, s85, 1023
    s_add_u32 m0, s87, 16384
    s_nop 0
    buffer_load_dwordx4 v134, s[8:11], s85 offen offset:0 lds
    v_mfma_f32_32x32x16_bf16 v[32:47], a[36:39], a[60:63], v[32:47]
    ds_read_b64_tr_b16 a[4:5], v133 offset:7200
    ds_read_b64_tr_b16 a[6:7], v133 offset:8096
    v_mfma_f32_32x32x16_bf16 v[48:63], a[40:43], a[60:63], v[48:63]
    ds_read_b64_tr_b16 a[8:9], v133 offset:7232
    ds_read_b64_tr_b16 a[10:11], v133 offset:8128
    s_waitcnt lgkmcnt(7)
    v_mfma_f32_32x32x16_bf16 v[64:79], a[44:47], a[60:63], v[64:79]
    ds_read_b64_tr_b16 a[12:13], v133 offset:7264
    ds_read_b64_tr_b16 a[14:15], v133 offset:8160
    s_mul_i32 s3, s85, 1792
    s_add_u32 m0, s88, 28928
    s_nop 0
    buffer_load_dwordx4 v138, s[28:31], s3 offen offset:0 lds
    v_mfma_f32_32x32x16_bf16 v[80:95], a[48:51], a[60:63], v[80:95]
    ds_read_b64_tr_b16 a[16:17], v133 offset:7296
    ds_read_b64_tr_b16 a[18:19], v133 offset:8192
    v_mfma_f32_32x32x16_bf16 v[96:111], a[52:55], a[60:63], v[96:111]
    ds_read_b64_tr_b16 a[20:21], v133 offset:7328
    ds_read_b64_tr_b16 a[22:23], v133 offset:8224
    v_mfma_f32_32x32x16_bf16 v[112:127], a[56:59], a[60:63], v[112:127]
    ds_read_b64_tr_b16 a[24:25], v133 offset:7360
    ds_read_b64_tr_b16 a[26:27], v133 offset:8256
    s_waitcnt lgkmcnt(8)
    v_mfma_f32_32x32x16_bf16 v[16:31], a[0:3], a[28:31], v[16:31]
    ds_read_b128 a[60:63], v131 offset:32768
    ds_read_b64_tr_b16 a[32:33], v133 offset:10752
    ds_read_b64_tr_b16 a[34:35], v133 offset:11648
    v_mfma_f32_32x32x16_bf16 v[32:47], a[4:7], a[28:31], v[32:47]
    ds_read_b64_tr_b16 a[36:37], v133 offset:10784
    ds_read_b64_tr_b16 a[38:39], v133 offset:11680
    v_mfma_f32_32x32x16_bf16 v[48:63], a[8:11], a[28:31], v[48:63]
    ds_read_b64_tr_b16 a[40:41], v133 offset:10816
    ds_read_b64_tr_b16 a[42:43], v133 offset:11712
    s_add_u32 m0, s87, 16384
    s_nop 0
    buffer_load_dwordx4 v135, s[8:11], s85 offen offset:1024 lds
    s_waitcnt lgkmcnt(7)
    v_mfma_f32_32x32x16_bf16 v[64:79], a[12:15], a[28:31], v[64:79]
    ds_read_b64_tr_b16 a[44:45], v133 offset:10848
    ds_read_b64_tr_b16 a[46:47], v133 offset:11744
    v_mfma_f32_32x32x16_bf16 v[80:95], a[16:19], a[28:31], v[80:95]
    ds_read_b64_tr_b16 a[48:49], v133 offset:10880
    ds_read_b64_tr_b16 a[50:51], v133 offset:11776
    buffer_load_dwordx4 v136, s[8:11], s85 offen offset:2048 lds
    v_mfma_f32_32x32x16_bf16 v[96:111], a[20:23], a[28:31], v[96:111]
    ds_read_b64_tr_b16 a[52:53], v133 offset:10912
    ds_read_b64_tr_b16 a[54:55], v133 offset:11808
    v_mfma_f32_32x32x16_bf16 v[112:127], a[24:27], a[28:31], v[112:127]
    ds_read_b64_tr_b16 a[56:57], v133 offset:10944
    ds_read_b64_tr_b16 a[58:59], v133 offset:11840
    s_waitcnt lgkmcnt(8)
    v_mfma_f32_32x32x16_bf16 v[16:31], a[32:35], a[60:63], v[16:31]
    s_waitcnt vmcnt(4)
    s_waitcnt lgkmcnt(0)
    s_barrier
    v_mfma_f32_32x32x16_bf16 v[32:47], a[36:39], a[60:63], v[32:47]
    ds_read_b128 a[28:31], v128 offset:0
    ds_read_b64_tr_b16 a[0:1], v132 offset:0
    ds_read_b64_tr_b16 a[2:3], v132 offset:896
    s_add_u32 m0, s87, 16384
    s_nop 0
    buffer_load_dwordx4 v137, s[8:11], s85 offen offset:3072 lds
    v_mfma_f32_32x32x16_bf16 v[48:63], a[40:43], a[60:63], v[48:63]
    ds_read_b64_tr_b16 a[4:5], v132 offset:32
    ds_read_b64_tr_b16 a[6:7], v132 offset:928
    ds_read_b64_tr_b16 a[8:9], v132 offset:64
    s_mul_i32 s3, s85, 1792
    s_add_u32 m0, s88, 28928
    s_nop 0
    buffer_load_dwordx4 v139, s[28:31], s3 offen offset:2048 lds
    v_mfma_f32_32x32x16_bf16 v[64:79], a[44:47], a[60:63], v[64:79]
    ds_read_b64_tr_b16 a[10:11], v132 offset:960
    ds_read_b64_tr_b16 a[12:13], v132 offset:96
    ds_read_b64_tr_b16 a[14:15], v132 offset:992
    v_mov_b32 v166, 0
    v_mov_b32 v167, 0
    v_mfma_f32_32x32x16_bf16 v[80:95], a[48:51], a[60:63], v[80:95]
    ds_read_b64_tr_b16 a[16:17], v132 offset:128
    ds_read_b64_tr_b16 a[18:19], v132 offset:1024
    s_add_u32 m0, s88, 33024
    s_nop 0
    buffer_load_dwordx4 v140, s[28:31], s3 offen offset:0 lds
    v_mov_b32 v168, 0
    v_mfma_f32_32x32x16_bf16 v[96:111], a[52:55], a[60:63], v[96:111]
    ds_read_b64_tr_b16 a[20:21], v132 offset:160
    ds_read_b64_tr_b16 a[22:23], v132 offset:1056
    v_mov_b32 v169, 0
    v_mfma_f32_32x32x16_bf16 v[112:127], a[56:59], a[60:63], v[112:127]
    ds_read_b64_tr_b16 a[24:25], v132 offset:192
    ds_read_b64_tr_b16 a[26:27], v132 offset:1088
    buffer_load_dwordx4 v141, s[28:31], s3 offen offset:2048 lds
    s_waitcnt lgkmcnt(8)
    v_mfma_f32_32x32x16_bf16 v[16:31], a[0:3], a[28:31], v[16:31]
    ds_read_b128 a[60:63], v129 offset:0
    ds_read_b64_tr_b16 a[32:33], v132 offset:3584
    ds_read_b64_tr_b16 a[34:35], v132 offset:4480
    v_mfma_f32_32x32x16_bf16 v[32:47], a[4:7], a[28:31], v[32:47]
    ds_read_b64_tr_b16 a[36:37], v132 offset:3616
    ds_read_b64_tr_b16 a[38:39], v132 offset:4512
    s_add_u32 m0, s88, 37120
    s_nop 0
    buffer_load_dwordx4 v142, s[28:31], s3 offen offset:0 lds
    v_mfma_f32_32x32x16_bf16 v[48:63], a[8:11], a[28:31], v[48:63]
    ds_read_b64_tr_b16 a[40:41], v132 offset:3648
    ds_read_b64_tr_b16 a[42:43], v132 offset:4544
    s_waitcnt lgkmcnt(7)
    v_mfma_f32_32x32x16_bf16 v[64:79], a[12:15], a[28:31], v[64:79]
    ds_read_b64_tr_b16 a[44:45], v132 offset:3680
    ds_read_b64_tr_b16 a[46:47], v132 offset:4576
    buffer_load_dwordx4 v143, s[28:31], s3 offen offset:2048 lds
    v_mfma_f32_32x32x16_bf16 v[80:95], a[16:19], a[28:31], v[80:95]
    ds_read_b64_tr_b16 a[48:49], v132 offset:3712
    ds_read_b64_tr_b16 a[50:51], v132 offset:4608
    s_mov_b32 exec_hi, 0xff
    ds_write_b128 v226, v[166:169]
    s_mov_b64 exec, -1
    v_mfma_f32_32x32x16_bf16 v[96:111], a[20:23], a[28:31], v[96:111]
    ds_read_b64_tr_b16 a[52:53], v132 offset:3744
    ds_read_b64_tr_b16 a[54:55], v132 offset:4640
    s_add_u32 m0, s88, 41216
    s_nop 0
    buffer_load_dwordx4 v144, s[28:31], s3 offen offset:0 lds
    v_mfma_f32_32x32x16_bf16 v[112:127], a[24:27], a[28:31], v[112:127]
    ds_read_b64_tr_b16 a[56:57], v132 offset:3776
    ds_read_b64_tr_b16 a[58:59], v132 offset:4672
    s_waitcnt lgkmcnt(9)
    v_mfma_f32_32x32x16_bf16 v[16:31], a[32:35], a[60:63], v[16:31]
    ds_read_b128 a[28:31], v130 offset:0
    ds_read_b64_tr_b16 a[0:1], v132 offset:7168
    ds_read_b64_tr_b16 a[2:3], v132 offset:8064
    v_mfma_f32_32x32x16_bf16 v[32:47], a[36:39], a[60:63], v[32:47]
    ds_read_b64_tr_b16 a[4:5], v132 offset:7200
    ds_read_b64_tr_b16 a[6:7], v132 offset:8096
    s_lshl_b32 s91, s5, 2
    s_lshr_b32 s90, s6, 3
    s_add_u32 s91, s91, s90
    s_lshl_b32 s91, s91, 11
    s_add_u32 s91, s91, 13631488
    v_and_b32 v6, 31, v0
    v_lshlrev_b32 v6, 6, v6
    buffer_load_dwordx2 v[4:5], v6, s[44:47], s91 offen sc1
    v_mfma_f32_32x32x16_bf16 v[48:63], a[40:43], a[60:63], v[48:63]
    ds_read_b64_tr_b16 a[8:9], v132 offset:7232
    ds_read_b64_tr_b16 a[10:11], v132 offset:8128
    ds_write_b128 v225, v[154:157] offset:32
    s_waitcnt lgkmcnt(8)
    v_mfma_f32_32x32x16_bf16 v[64:79], a[44:47], a[60:63], v[64:79]
    ds_read_b64_tr_b16 a[12:13], v132 offset:7264
    ds_read_b64_tr_b16 a[14:15], v132 offset:8160
    s_lshl_b32 s101, s56, 4
    s_add_u32 m0, s99, 32768
    s_nop 0
    buffer_load_dwordx4 v230, s[32:35], s101 offen lds
    buffer_load_dwordx4 v231, s[32:35], s101 offen offset:1024 lds
    v_mfma_f32_32x32x16_bf16 v[80:95], a[48:51], a[60:63], v[80:95]
    ds_read_b64_tr_b16 a[16:17], v132 offset:7296
    ds_read_b64_tr_b16 a[18:19], v132 offset:8192
    v_mfma_f32_32x32x16_bf16 v[96:111], a[52:55], a[60:63], v[96:111]
    ds_read_b64_tr_b16 a[20:21], v132 offset:7328
    ds_read_b64_tr_b16 a[22:23], v132 offset:8224
    v_mfma_f32_32x32x16_bf16 v[112:127], a[56:59], a[60:63], v[112:127]
    ds_read_b64_tr_b16 a[24:25], v132 offset:7360
    ds_read_b64_tr_b16 a[26:27], v132 offset:8256
    v_alignbit_b32 v146, v155, v154, 16
    v_alignbit_b32 v147, v156, v155, 16
    s_waitcnt lgkmcnt(9)
    v_mfma_f32_32x32x16_bf16 v[16:31], a[0:3], a[28:31], v[16:31]
    ds_read_b128 a[60:63], v131 offset:0
    ds_read_b64_tr_b16 a[32:33], v132 offset:10752
    ds_read_b64_tr_b16 a[34:35], v132 offset:11648
    s_lshl_b32 s101, s60, 4
    s_add_u32 m0, s99, 40960
    s_nop 0
    buffer_load_dwordx4 v230, s[32:35], s101 offen lds
    buffer_load_dwordx4 v231, s[32:35], s101 offen offset:1024 lds
    v_mfma_f32_32x32x16_bf16 v[32:47], a[4:7], a[28:31], v[32:47]
    ds_read_b64_tr_b16 a[36:37], v132 offset:10784
    ds_read_b64_tr_b16 a[38:39], v132 offset:11680
    v_alignbit_b32 v148, v157, v156, 16
    v_alignbit_b32 v149, v158, v157, 16
    ds_write_b128 v225, v[146:149] offset:4192
    v_mfma_f32_32x32x16_bf16 v[48:63], a[8:11], a[28:31], v[48:63]
    ds_read_b64_tr_b16 a[40:41], v132 offset:10816
    ds_read_b64_tr_b16 a[42:43], v132 offset:11712
    s_waitcnt lgkmcnt(8)
    v_mfma_f32_32x32x16_bf16 v[64:79], a[12:15], a[28:31], v[64:79]
    ds_read_b64_tr_b16 a[44:45], v132 offset:10848
    ds_read_b64_tr_b16 a[46:47], v132 offset:11744
    v_mfma_f32_32x32x16_bf16 v[80:95], a[16:19], a[28:31], v[80:95]
    ds_read_b64_tr_b16 a[48:49], v132 offset:10880
    ds_read_b64_tr_b16 a[50:51], v132 offset:11776
    v_mfma_f32_32x32x16_bf16 v[96:111], a[20:23], a[28:31], v[96:111]
    ds_read_b64_tr_b16 a[52:53], v132 offset:10912
    ds_read_b64_tr_b16 a[54:55], v132 offset:11808
    ds_write_b128 v225, v[160:163] offset:2080
    v_mfma_f32_32x32x16_bf16 v[112:127], a[24:27], a[28:31], v[112:127]
    ds_read_b64_tr_b16 a[56:57], v132 offset:10944
    ds_read_b64_tr_b16 a[58:59], v132 offset:11840
    s_waitcnt lgkmcnt(9)
    v_mfma_f32_32x32x16_bf16 v[16:31], a[32:35], a[60:63], v[16:31]
    s_waitcnt vmcnt(5)
    s_waitcnt lgkmcnt(0)
    s_barrier
    v_lshlrev_b32 v166, 16, v154
    s_mov_b64 exec, 1
    ds_write_b32 v248, v166 offset:4188
    ds_write_b32 v248, v154 offset:8348
    ds_write_b32 v248, v166 offset:12504
    ds_write_b32 v248, v146 offset:12508
    s_mov_b64 exec, -1
    v_mfma_f32_32x32x16_bf16 v[32:47], a[36:39], a[60:63], v[32:47]
    ds_read_b128 a[0:3], v128 offset:16384
    ds_read_b128 a[4:7], v129 offset:16384
    ds_read_b128 a[8:11], v130 offset:16384
    v_mfma_f32_32x32x16_bf16 v[48:63], a[40:43], a[60:63], v[48:63]
    ds_read_b128 a[12:15], v131 offset:16384
    ds_read_b64_tr_b16 a[16:17], v132 offset:28928
    ds_read_b64_tr_b16 a[18:19], v132 offset:29824
    v_mfma_f32_32x32x16_bf16 v[64:79], a[44:47], a[60:63], v[64:79]
    ds_read_b64_tr_b16 a[20:21], v132 offset:32512
    ds_read_b64_tr_b16 a[22:23], v132 offset:33408
    ds_read_b64_tr_b16 a[24:25], v132 offset:36096
    s_waitcnt vmcnt(4)
    v_cmp_ne_u64 vcc, v[2:3], v[4:5]
    s_cbranch_vccz L_ok_f1_3
    s_mov_b32 s1, 0
L_spin_f1_4:
    s_sleep 1
    buffer_load_dwordx2 v[4:5], v6, s[44:47], s91 offen sc1
    s_waitcnt vmcnt(0)
    v_cmp_ne_u64 vcc, v[2:3], v[4:5]
    s_cbranch_vccz L_ok_f1_3
    s_add_u32 s1, s1, 1
    s_cmp_lt_u32 s1, 0x10000
    s_cbranch_scc1 L_spin_f1_4
L_ok_f1_3:
    s_add_u32 s90, s98, 0
    s_lshl_b32 s91, s53, 11
    s_add_u32 s91, s91, s96
    s_add_u32 m0, s91, 512
    s_nop 0
    buffer_load_dwordx4 v1, s[44:47], s90 offen sc1 lds
    buffer_load_dwordx4 v1, s[44:47], s90 offen offset:1024 sc1 lds
    v_mfma_f32_32x32x16_bf16 v[80:95], a[48:51], a[60:63], v[80:95]
    ds_read_b64_tr_b16 a[26:27], v132 offset:36992
    ds_read_b64_tr_b16 a[28:29], v132 offset:39680
    v_mfma_f32_32x32x16_bf16 v[96:111], a[52:55], a[60:63], v[96:111]
    ds_read_b64_tr_b16 a[30:31], v132 offset:40576
    s_lshl_b32 s101, s64, 4
    s_add_u32 m0, s99, 0
    s_nop 0
    buffer_load_dwordx4 v230, s[32:35], s101 offen lds
    buffer_load_dwordx4 v231, s[32:35], s101 offen offset:1024 lds
    v_mfma_f32_32x32x16_bf16 v[112:127], a[56:59], a[60:63], v[112:127]
    s_waitcnt lgkmcnt(6)
    v_mfma_f32_32x32x16_bf16 v[16:31], a[16:19], a[0:3], v[16:31]
    ds_read_b64_tr_b16 a[32:33], v132 offset:28960
    ds_read_b64_tr_b16 a[34:35], v132 offset:29856
    s_waitcnt lgkmcnt(6)
    v_mfma_f32_32x32x16_bf16 v[16:31], a[20:23], a[4:7], v[16:31]
    ds_read_b64_tr_b16 a[36:37], v132 offset:32544
    ds_read_b64_tr_b16 a[38:39], v132 offset:33440
    s_waitcnt lgkmcnt(6)
    v_mfma_f32_32x32x16_bf16 v[16:31], a[24:27], a[8:11], v[16:31]
    ds_read_b64_tr_b16 a[40:41], v132 offset:36128
    ds_read_b64_tr_b16 a[42:43], v132 offset:37024
    s_lshl_b32 s101, s57, 4
    s_add_u32 m0, s99, 8192
    s_nop 0
    buffer_load_dwordx4 v230, s[32:35], s101 offen lds
    buffer_load_dwordx4 v231, s[32:35], s101 offen offset:1024 lds
    s_waitcnt lgkmcnt(6)
    v_mfma_f32_32x32x16_bf16 v[16:31], a[28:31], a[12:15], v[16:31]
    ds_read_b64_tr_b16 a[44:45], v132 offset:39712
    ds_read_b64_tr_b16 a[46:47], v132 offset:40608
    s_waitcnt lgkmcnt(6)
    v_mfma_f32_32x32x16_bf16 v[32:47], a[32:35], a[0:3], v[32:47]
    ds_read_b64_tr_b16 a[16:17], v132 offset:28992
    ds_read_b64_tr_b16 a[18:19], v132 offset:29888
    s_waitcnt lgkmcnt(6)
    v_mfma_f32_32x32x16_bf16 v[32:47], a[36:39], a[4:7], v[32:47]
    ds_read_b64_tr_b16 a[20:21], v132 offset:32576
    ds_read_b64_tr_b16 a[22:23], v132 offset:33472
    s_nop 1
    v_max_f32 v16, 0, v16
    v_max_f32 v17, 0, v17
    v_max_f32 v18, 0, v18
    v_max_f32 v19, 0, v19
    s_waitcnt lgkmcnt(6)
    v_mfma_f32_32x32x16_bf16 v[32:47], a[40:43], a[8:11], v[32:47]
    ds_read_b64_tr_b16 a[24:25], v132 offset:36160
    ds_read_b64_tr_b16 a[26:27], v132 offset:37056
    v_max_f32 v20, 0, v20
    v_max_f32 v21, 0, v21
    v_max_f32 v22, 0, v22
    v_max_f32 v23, 0, v23
    v_mul_f32 v16, v16, v24
    v_mul_f32 v17, v17, v25
    v_mul_f32 v18, v18, v26
    v_mul_f32 v19, v19, v27
    v_mul_f32 v20, v20, v28
    s_lshl_b32 s101, s58, 4
    s_add_u32 m0, s99, 49152
    s_nop 0
    buffer_load_dwordx4 v230, s[32:35], s101 offen lds
    buffer_load_dwordx4 v231, s[32:35], s101 offen offset:1024 lds
    s_waitcnt lgkmcnt(6)
    v_mfma_f32_32x32x16_bf16 v[32:47], a[44:47], a[12:15], v[32:47]
    ds_read_b64_tr_b16 a[28:29], v132 offset:39744
    ds_read_b64_tr_b16 a[30:31], v132 offset:40640
    v_mul_f32 v21, v21, v29
    v_mul_f32 v22, v22, v30
    v_mul_f32 v23, v23, v31
    v_cvt_pk_bf16_f32 v24, v16, v17
    v_cvt_pk_bf16_f32 v25, v18, v19
    v_cvt_pk_bf16_f32 v26, v20, v21
    v_cvt_pk_bf16_f32 v27, v22, v23
    buffer_store_dwordx4 v[24:27], v1, s[44:47], s89 offen offset:0 sc1
    s_waitcnt lgkmcnt(6)
    v_mfma_f32_32x32x16_bf16 v[48:63], a[16:19], a[0:3], v[48:63]
    ds_read_b64_tr_b16 a[32:33], v132 offset:29024
    ds_read_b64_tr_b16 a[34:35], v132 offset:29920
    s_waitcnt lgkmcnt(6)
    v_mfma_f32_32x32x16_bf16 v[48:63], a[20:23], a[4:7], v[48:63]
    ds_read_b64_tr_b16 a[36:37], v132 offset:32608
    ds_read_b64_tr_b16 a[38:39], v132 offset:33504
    v_max_f32 v32, 0, v32
    v_max_f32 v33, 0, v33
    v_max_f32 v34, 0, v34
    v_max_f32 v35, 0, v35
    s_waitcnt lgkmcnt(6)
    v_mfma_f32_32x32x16_bf16 v[48:63], a[24:27], a[8:11], v[48:63]
    ds_read_b64_tr_b16 a[40:41], v132 offset:36192
    ds_read_b64_tr_b16 a[42:43], v132 offset:37088
    v_max_f32 v36, 0, v36
    v_max_f32 v37, 0, v37
    v_max_f32 v38, 0, v38
    v_max_f32 v39, 0, v39
    v_mul_f32 v32, v32, v40
    v_mul_f32 v33, v33, v41
    v_mul_f32 v34, v34, v42
    v_mul_f32 v35, v35, v43
    v_mul_f32 v36, v36, v44
    s_lshl_b32 s101, s59, 4
    s_add_u32 m0, s99, 57344
    s_nop 0
    buffer_load_dwordx4 v230, s[32:35], s101 offen lds
    buffer_load_dwordx4 v231, s[32:35], s101 offen offset:1024 lds
    s_waitcnt lgkmcnt(6)
    v_mfma_f32_32x32x16_bf16 v[48:63], a[28:31], a[12:15], v[48:63]
    ds_read_b64_tr_b16 a[44:45], v132 offset:39776
    ds_read_b64_tr_b16 a[46:47], v132 offset:40672
    v_mul_f32 v37, v37, v45
    v_mul_f32 v38, v38, v46
    v_mul_f32 v39, v39, v47
    v_cvt_pk_bf16_f32 v40, v32, v33
    v_cvt_pk_bf16_f32 v41, v34, v35
    v_cvt_pk_bf16_f32 v42, v36, v37
    v_cvt_pk_bf16_f32 v43, v38, v39
    buffer_store_dwordx4 v[40:43], v1, s[44:47], s89 offen offset:1024 sc1
    s_waitcnt lgkmcnt(6)
    v_mfma_f32_32x32x16_bf16 v[64:79], a[32:35], a[0:3], v[64:79]
    ds_read_b64_tr_b16 a[16:17], v132 offset:29056
    ds_read_b64_tr_b16 a[18:19], v132 offset:29952
    s_waitcnt lgkmcnt(6)
    v_mfma_f32_32x32x16_bf16 v[64:79], a[36:39], a[4:7], v[64:79]
    ds_read_b64_tr_b16 a[20:21], v132 offset:32640
    ds_read_b64_tr_b16 a[22:23], v132 offset:33536
    v_max_f32 v48, 0, v48
    v_max_f32 v49, 0, v49
    v_max_f32 v50, 0, v50
    v_max_f32 v51, 0, v51
    s_waitcnt lgkmcnt(6)
    v_mfma_f32_32x32x16_bf16 v[64:79], a[40:43], a[8:11], v[64:79]
    ds_read_b64_tr_b16 a[24:25], v132 offset:36224
    ds_read_b64_tr_b16 a[26:27], v132 offset:37120
    v_max_f32 v52, 0, v52
    v_max_f32 v53, 0, v53
    v_max_f32 v54, 0, v54
    v_max_f32 v55, 0, v55
    v_mul_f32 v48, v48, v56
    v_mul_f32 v49, v49, v57
    v_mul_f32 v50, v50, v58
    v_mul_f32 v51, v51, v59
    v_mul_f32 v52, v52, v60
    s_lshl_b32 s101, s68, 4
    s_add_u32 m0, s99, 65536
    s_nop 0
    buffer_load_dwordx4 v230, s[32:35], s101 offen lds
    buffer_load_dwordx4 v231, s[32:35], s101 offen offset:1024 lds
    s_waitcnt lgkmcnt(6)
    v_mfma_f32_32x32x16_bf16 v[64:79], a[44:47], a[12:15], v[64:79]
    ds_read_b64_tr_b16 a[28:29], v132 offset:39808
    ds_read_b64_tr_b16 a[30:31], v132 offset:40704
    v_mul_f32 v53, v53, v61
    v_mul_f32 v54, v54, v62
    v_mul_f32 v55, v55, v63
    v_cvt_pk_bf16_f32 v56, v48, v49
    v_cvt_pk_bf16_f32 v57, v50, v51
    v_cvt_pk_bf16_f32 v58, v52, v53
    v_cvt_pk_bf16_f32 v59, v54, v55
    buffer_store_dwordx4 v[56:59], v1, s[44:47], s89 offen offset:2048 sc1
    s_waitcnt lgkmcnt(6)
    v_mfma_f32_32x32x16_bf16 v[80:95], a[16:19], a[0:3], v[80:95]
    ds_read_b64_tr_b16 a[32:33], v132 offset:29088
    ds_read_b64_tr_b16 a[34:35], v132 offset:29984
    s_waitcnt lgkmcnt(6)
    v_mfma_f32_32x32x16_bf16 v[80:95], a[20:23], a[4:7], v[80:95]
    ds_read_b64_tr_b16 a[36:37], v132 offset:32672
    ds_read_b64_tr_b16 a[38:39], v132 offset:33568
    v_max_f32 v64, 0, v64
    v_max_f32 v65, 0, v65
    v_max_f32 v66, 0, v66
    v_max_f32 v67, 0, v67
    s_waitcnt lgkmcnt(6)
    v_mfma_f32_32x32x16_bf16 v[80:95], a[24:27], a[8:11], v[80:95]
    ds_read_b64_tr_b16 a[40:41], v132 offset:36256
    ds_read_b64_tr_b16 a[42:43], v132 offset:37152
    v_max_f32 v68, 0, v68
    v_max_f32 v69, 0, v69
    v_max_f32 v70, 0, v70
    v_max_f32 v71, 0, v71
    v_mul_f32 v64, v64, v72
    v_mul_f32 v65, v65, v73
    v_mul_f32 v66, v66, v74
    v_mul_f32 v67, v67, v75
    v_mul_f32 v68, v68, v76
    s_waitcnt lgkmcnt(6)
    v_mfma_f32_32x32x16_bf16 v[80:95], a[28:31], a[12:15], v[80:95]
    ds_read_b64_tr_b16 a[44:45], v132 offset:39840
    ds_read_b64_tr_b16 a[46:47], v132 offset:40736
    v_mul_f32 v69, v69, v77
    v_mul_f32 v70, v70, v78
    v_mul_f32 v71, v71, v79
    v_cvt_pk_bf16_f32 v72, v64, v65
    v_cvt_pk_bf16_f32 v73, v66, v67
    v_cvt_pk_bf16_f32 v74, v68, v69
    v_cvt_pk_bf16_f32 v75, v70, v71
    buffer_store_dwordx4 v[72:75], v1, s[44:47], s89 offen offset:3072 sc1
    s_waitcnt lgkmcnt(6)
    v_mfma_f32_32x32x16_bf16 v[96:111], a[32:35], a[0:3], v[96:111]
    ds_read_b64_tr_b16 a[16:17], v132 offset:29120
    ds_read_b64_tr_b16 a[18:19], v132 offset:30016
    s_waitcnt lgkmcnt(6)
    v_mfma_f32_32x32x16_bf16 v[96:111], a[36:39], a[4:7], v[96:111]
    ds_read_b64_tr_b16 a[20:21], v132 offset:32704
    ds_read_b64_tr_b16 a[22:23], v132 offset:33600
    v_max_f32 v80, 0, v80
    v_max_f32 v81, 0, v81
    v_max_f32 v82, 0, v82
    v_max_f32 v83, 0, v83
    s_waitcnt lgkmcnt(6)
    v_mfma_f32_32x32x16_bf16 v[96:111], a[40:43], a[8:11], v[96:111]
    ds_read_b64_tr_b16 a[24:25], v132 offset:36288
    ds_read_b64_tr_b16 a[26:27], v132 offset:37184
    v_max_f32 v84, 0, v84
    v_max_f32 v85, 0, v85
    v_max_f32 v86, 0, v86
    v_max_f32 v87, 0, v87
    v_mul_f32 v80, v80, v88
    v_mul_f32 v81, v81, v89
    v_mul_f32 v82, v82, v90
    v_mul_f32 v83, v83, v91
    v_mul_f32 v84, v84, v92
    s_waitcnt lgkmcnt(6)
    v_mfma_f32_32x32x16_bf16 v[96:111], a[44:47], a[12:15], v[96:111]
    ds_read_b64_tr_b16 a[28:29], v132 offset:39872
    ds_read_b64_tr_b16 a[30:31], v132 offset:40768
    v_mul_f32 v85, v85, v93
    v_mul_f32 v86, v86, v94
    v_mul_f32 v87, v87, v95
    v_cvt_pk_bf16_f32 v88, v80, v81
    v_cvt_pk_bf16_f32 v89, v82, v83
    v_cvt_pk_bf16_f32 v90, v84, v85
    v_cvt_pk_bf16_f32 v91, v86, v87
    s_add_u32 s89, s89, 4096
    buffer_store_dwordx4 v[88:91], v1, s[44:47], s89 offen offset:0 sc1
    s_waitcnt lgkmcnt(6)
    v_mfma_f32_32x32x16_bf16 v[112:127], a[16:19], a[0:3], v[112:127]
    s_waitcnt lgkmcnt(4)
    v_mfma_f32_32x32x16_bf16 v[112:127], a[20:23], a[4:7], v[112:127]
    v_max_f32 v96, 0, v96
    v_max_f32 v97, 0, v97
    v_max_f32 v98, 0, v98
    v_max_f32 v99, 0, v99
    s_waitcnt lgkmcnt(2)
    v_mfma_f32_32x32x16_bf16 v[112:127], a[24:27], a[8:11], v[112:127]
    v_max_f32 v100, 0, v100
    v_max_f32 v101, 0, v101
    v_max_f32 v102, 0, v102
    v_max_f32 v103, 0, v103
    v_mul_f32 v96, v96, v104
    v_mul_f32 v97, v97, v105
    v_mul_f32 v98, v98, v106
    v_mul_f32 v99, v99, v107
    v_mul_f32 v100, v100, v108
    s_waitcnt lgkmcnt(0)
    v_mfma_f32_32x32x16_bf16 v[112:127], a[28:31], a[12:15], v[112:127]
    v_mul_f32 v101, v101, v109
    v_mul_f32 v102, v102, v110
    v_mul_f32 v103, v103, v111
    v_cvt_pk_bf16_f32 v104, v96, v97
    v_cvt_pk_bf16_f32 v105, v98, v99
    v_cvt_pk_bf16_f32 v106, v100, v101
    v_cvt_pk_bf16_f32 v107, v102, v103
    buffer_store_dwordx4 v[104:107], v1, s[44:47], s89 offen offset:1024 sc1
    s_nop 3
    v_max_f32 v112, 0, v112
    v_max_f32 v113, 0, v113
    v_max_f32 v114, 0, v114
    v_max_f32 v115, 0, v115
    v_max_f32 v116, 0, v116
    v_max_f32 v117, 0, v117
    v_max_f32 v118, 0, v118
    v_max_f32 v119, 0, v119
    v_mul_f32 v112, v112, v120
    v_mul_f32 v113, v113, v121
    v_mul_f32 v114, v114, v122
    v_mul_f32 v115, v115, v123
    v_mul_f32 v116, v116, v124
    v_mul_f32 v117, v117, v125
    v_mul_f32 v118, v118, v126
    v_mul_f32 v119, v119, v127
    v_cvt_pk_bf16_f32 v120, v112, v113
    v_cvt_pk_bf16_f32 v121, v114, v115
    v_cvt_pk_bf16_f32 v122, v116, v117
    v_cvt_pk_bf16_f32 v123, v118, v119
    buffer_store_dwordx4 v[120:123], v1, s[44:47], s89 offen offset:2048 sc1
    s_waitcnt vmcnt(17)
    s_waitcnt lgkmcnt(0)
    s_barrier
    ds_read_b64 v[144:145], v222 offset:0
    ds_read_b64 v[146:147], v222 offset:8
    ds_read_b128 v[28:31], v223 offset:384
    ds_read_b128 v[44:47], v223 offset:896
    ds_read_b128 v[60:63], v223 offset:1408
    ds_read_b128 v[76:79], v223 offset:1920
    ds_read_b128 v[92:95], v223 offset:2432
    ds_read_b128 v[108:111], v223 offset:2944
    ds_read_b128 v[124:127], v223 offset:3456
    ds_read_b128 v[140:143], v223 offset:3968
    ds_read_b64 v[148:149], v222 offset:128
    ds_read_b64 v[150:151], v222 offset:136
    ds_read_b64 v[152:153], v222 offset:256
    ds_read_b64 v[154:155], v222 offset:264
    s_waitcnt lgkmcnt(11)
    v_mfma_f32_16x16x32_bf16 v[176:179], v[144:147], v[28:31], 0
    ds_read_b128 v[24:27], v223 offset:256
    ds_read_b128 v[40:43], v223 offset:768
    s_waitcnt lgkmcnt(12)
    v_mfma_f32_16x16x32_bf16 v[180:183], v[144:147], v[44:47], 0
    ds_read_b128 v[56:59], v223 offset:1280
    ds_read_b128 v[72:75], v223 offset:1792
    s_waitcnt lgkmcnt(13)
    v_mfma_f32_16x16x32_bf16 v[184:187], v[144:147], v[60:63], 0
    ds_read_b128 v[88:91], v223 offset:2304
    ds_read_b128 v[104:107], v223 offset:2816
    s_waitcnt lgkmcnt(14)
    v_mfma_f32_16x16x32_bf16 v[188:191], v[144:147], v[76:79], 0
    ds_read_b128 v[120:123], v223 offset:3328
    ds_read_b128 v[136:139], v223 offset:3840
    s_waitcnt lgkmcnt(15)
    v_mfma_f32_16x16x32_bf16 v[192:195], v[144:147], v[92:95], 0
    ds_read_b64 v[156:157], v222 offset:384
    ds_read_b64 v[158:159], v222 offset:392
    s_waitcnt lgkmcnt(15)
    v_mfma_f32_16x16x32_bf16 v[196:199], v[144:147], v[108:111], 0
    s_lshl_b32 s101, s61, 4
    s_add_u32 m0, s99, 16384
    s_nop 0
    buffer_load_dwordx4 v230, s[32:35], s101 offen lds
    buffer_load_dwordx4 v231, s[32:35], s101 offen offset:1024 lds
    s_waitcnt lgkmcnt(15)
    v_mfma_f32_16x16x32_bf16 v[200:203], v[144:147], v[124:127], 0
    s_lshl_b32 s101, s62, 4
    s_add_u32 m0, s99, 24576
    s_nop 0
    buffer_load_dwordx4 v230, s[32:35], s101 offen lds
    buffer_load_dwordx4 v231, s[32:35], s101 offen offset:1024 lds
    s_waitcnt lgkmcnt(14)
    v_mfma_f32_16x16x32_bf16 v[204:207], v[144:147], v[140:143], 0
    s_lshl_b32 s101, s63, 4
    s_add_u32 m0, s99, 73728
    s_nop 0
    buffer_load_dwordx4 v230, s[32:35], s101 offen lds
    buffer_load_dwordx4 v231, s[32:35], s101 offen offset:1024 lds
    s_waitcnt lgkmcnt(9)
    v_mfma_f32_16x16x32_bf16 v[176:179], v[148:151], v[24:27], v[176:179]
    ds_read_b128 v[20:23], v223 offset:128
    ds_read_b128 v[36:39], v223 offset:640
    s_waitcnt lgkmcnt(10)
    v_mfma_f32_16x16x32_bf16 v[180:183], v[148:151], v[40:43], v[180:183]
    ds_read_b128 v[52:55], v223 offset:1152
    ds_read_b128 v[68:71], v223 offset:1664
    s_waitcnt lgkmcnt(11)
    v_mfma_f32_16x16x32_bf16 v[184:187], v[148:151], v[56:59], v[184:187]
    ds_read_b128 v[84:87], v223 offset:2176
    ds_read_b128 v[100:103], v223 offset:2688
    s_waitcnt lgkmcnt(12)
    v_mfma_f32_16x16x32_bf16 v[188:191], v[148:151], v[72:75], v[188:191]
    ds_read_b128 v[116:119], v223 offset:3200
    ds_read_b128 v[132:135], v223 offset:3712
    s_waitcnt lgkmcnt(13)
    v_mfma_f32_16x16x32_bf16 v[192:195], v[148:151], v[88:91], v[192:195]
    ds_read_b64 v[160:161], v222 offset:512
    ds_read_b64 v[162:163], v222 offset:520
    s_waitcnt lgkmcnt(14)
    v_mfma_f32_16x16x32_bf16 v[196:199], v[148:151], v[104:107], v[196:199]
    s_lshl_b32 s101, s72, 4
    s_add_u32 m0, s99, 81920
    s_nop 0
    buffer_load_dwordx4 v230, s[32:35], s101 offen lds
    buffer_load_dwordx4 v231, s[32:35], s101 offen offset:1024 lds
    s_waitcnt lgkmcnt(13)
    v_mfma_f32_16x16x32_bf16 v[200:203], v[148:151], v[120:123], v[200:203]
    ds_read_b64_tr_b16 a[0:1], v232 offset:32768
    s_waitcnt lgkmcnt(13)
    v_mfma_f32_16x16x32_bf16 v[204:207], v[148:151], v[136:139], v[204:207]
    ds_read_b64_tr_b16 a[2:3], v232 offset:33792
    ds_read_b64_tr_b16 a[4:5], v233 offset:32768
    s_waitcnt lgkmcnt(12)
    v_mfma_f32_16x16x32_bf16 v[176:179], v[152:155], v[20:23], v[176:179]
    ds_read_b128 v[16:19], v223 offset:0
    ds_read_b128 v[32:35], v223 offset:512
    s_waitcnt lgkmcnt(13)
    v_mfma_f32_16x16x32_bf16 v[180:183], v[152:155], v[36:39], v[180:183]
    ds_read_b128 v[48:51], v223 offset:1024
    ds_read_b128 v[64:67], v223 offset:1536
    s_waitcnt lgkmcnt(14)
    v_mfma_f32_16x16x32_bf16 v[184:187], v[152:155], v[52:55], v[184:187]
    ds_read_b128 v[80:83], v223 offset:2048
    ds_read_b128 v[96:99], v223 offset:2560
    s_waitcnt lgkmcnt(15)
    v_mfma_f32_16x16x32_bf16 v[188:191], v[152:155], v[68:71], v[188:191]
    ds_read_b128 v[112:115], v223 offset:3072
    ds_read_b128 v[128:131], v223 offset:3584
    s_waitcnt lgkmcnt(15)
    v_mfma_f32_16x16x32_bf16 v[192:195], v[152:155], v[84:87], v[192:195]
    ds_read_b64 v[164:165], v222 offset:640
    ds_read_b64 v[166:167], v222 offset:648
    s_waitcnt lgkmcnt(15)
    v_mfma_f32_16x16x32_bf16 v[196:199], v[152:155], v[100:103], v[196:199]
    ds_read_b64_tr_b16 a[6:7], v233 offset:33792
    ds_read_b64_tr_b16 a[32:33], v232 offset:40960
    s_waitcnt lgkmcnt(15)
    v_mfma_f32_16x16x32_bf16 v[200:203], v[152:155], v[116:119], v[200:203]
    ds_read_b64_tr_b16 a[34:35], v232 offset:41984
    ds_read_b64_tr_b16 a[36:37], v233 offset:40960
    s_waitcnt lgkmcnt(15)
    v_mfma_f32_16x16x32_bf16 v[204:207], v[152:155], v[132:135], v[204:207]
    ds_read_b64_tr_b16 a[38:39], v233 offset:41984
    s_waitcnt lgkmcnt(4)
    s_lshl_b32 s101, s65, 4
    s_add_u32 m0, s99, 32768
    s_nop 0
    buffer_load_dwordx4 v230, s[32:35], s101 offen lds
    buffer_load_dwordx4 v231, s[32:35], s101 offen offset:1024 lds
    v_mfma_f32_16x16x32_bf16 v[176:179], v[156:159], v[16:19], v[176:179]
    ds_read_b64 v[168:169], v222 offset:768
    s_waitcnt vmcnt(25)
    ds_read_b64_tr_b16 a[64:65], v232 offset:0
    v_mfma_f32_16x16x32_bf16 v[180:183], v[156:159], v[32:35], v[180:183]
    ds_read_b64 v[170:171], v222 offset:776
    ds_read_b64_tr_b16 a[66:67], v232 offset:1024
    v_mfma_f32_16x16x32_bf16 v[184:187], v[156:159], v[48:51], v[184:187]
    ds_read_b64_tr_b16 a[68:69], v233 offset:0
    ds_read_b64_tr_b16 a[70:71], v233 offset:1024
    v_mfma_f32_16x16x32_bf16 v[188:191], v[156:159], v[64:67], v[188:191]
    s_waitcnt lgkmcnt(6)
    s_lshl_b32 s101, s66, 4
    s_add_u32 m0, s99, 40960
    s_nop 0
    buffer_load_dwordx4 v230, s[32:35], s101 offen lds
    buffer_load_dwordx4 v231, s[32:35], s101 offen offset:1024 lds
    v_mfma_f32_16x16x32_bf16 v[192:195], v[156:159], v[80:83], v[192:195]
    s_waitcnt vmcnt(25)
    ds_read_b64_tr_b16 a[8:9], v232 offset:8192
    v_mfma_f32_16x16x32_bf16 v[196:199], v[156:159], v[96:99], v[196:199]
    ds_read_b64_tr_b16 a[10:11], v232 offset:9216
    ds_read_b64_tr_b16 a[12:13], v233 offset:8192
    v_mfma_f32_16x16x32_bf16 v[200:203], v[156:159], v[112:115], v[200:203]
    ds_read_b64_tr_b16 a[14:15], v233 offset:9216
    s_waitcnt lgkmcnt(4)
    s_lshl_b32 s101, s67, 4
    s_add_u32 m0, s99, 0
    s_nop 0
    buffer_load_dwordx4 v230, s[32:35], s101 offen lds
    buffer_load_dwordx4 v231, s[32:35], s101 offen offset:1024 lds
    v_mfma_f32_16x16x32_bf16 v[204:207], v[156:159], v[128:131], v[204:207]
    s_waitcnt vmcnt(25)
    ds_read_b64_tr_b16 a[16:17], v232 offset:49152
    v_mfma_f32_16x16x32_bf16 v[180:183], v[160:163], v[28:31], v[180:183]
    ds_read_b64 v[172:173], v222 offset:896
    ds_read_b64_tr_b16 a[18:19], v232 offset:50176
    v_mfma_f32_16x16x32_bf16 v[184:187], v[160:163], v[44:47], v[184:187]
    ds_read_b64 v[174:175], v222 offset:904
    ds_read_b64_tr_b16 a[20:21], v233 offset:49152
    v_mfma_f32_16x16x32_bf16 v[188:191], v[160:163], v[60:63], v[188:191]
    ds_read_b64_tr_b16 a[22:23], v233 offset:50176
    s_waitcnt lgkmcnt(6)
    s_lshl_b32 s101, s76, 4
    s_add_u32 m0, s99, 8192
    s_nop 0
    buffer_load_dwordx4 v230, s[32:35], s101 offen lds
    buffer_load_dwordx4 v231, s[32:35], s101 offen offset:1024 lds
    v_mfma_f32_16x16x32_bf16 v[192:195], v[160:163], v[76:79], v[192:195]
    s_waitcnt vmcnt(24)
    ds_read_b64_tr_b16 a[24:25], v232 offset:57344
    v_mfma_f32_16x16x32_bf16 v[196:199], v[160:163], v[92:95], v[196:199]
    ds_read_b64_tr_b16 a[26:27], v232 offset:58368
    ds_read_b64_tr_b16 a[28:29], v233 offset:57344
    v_mfma_f32_16x16x32_bf16 v[200:203], v[160:163], v[108:111], v[200:203]
    ds_read_b64_tr_b16 a[30:31], v233 offset:58368
    s_waitcnt lgkmcnt(4)
    s_lshl_b32 s101, s69, 4
    s_add_u32 m0, s99, 49152
    s_nop 0
    buffer_load_dwordx4 v230, s[32:35], s101 offen lds
    buffer_load_dwordx4 v231, s[32:35], s101 offen offset:1024 lds
    v_mfma_f32_16x16x32_bf16 v[204:207], v[160:163], v[124:127], v[204:207]
    s_waitcnt vmcnt(23)
    ds_read_b64_tr_b16 a[96:97], v234 offset:0
    v_mfma_f32_16x16x32_bf16 v[180:183], v[164:167], v[24:27], v[180:183]
    ds_read_b64 v[144:145], v222 offset:1024
    ds_read_b64_tr_b16 a[98:99], v234 offset:1024
    v_mfma_f32_16x16x32_bf16 v[184:187], v[164:167], v[40:43], v[184:187]
    ds_read_b64 v[146:147], v222 offset:1032
    s_waitcnt vmcnt(18)
    s_lshl_b32 s90, s54, 2
    s_add_u32 s90, s90, s4
    s_lshl_b32 s90, s90, 4
    s_add_u32 s90, s90, s55
    s_lshl_b32 s90, s90, 6
    s_add_u32 s90, s90, 13697024
    s_mov_b64 exec, 1
    buffer_store_dwordx2 v[2:3], off, s[44:47], s90 sc1
    s_mov_b64 exec, -1
    v_mfma_f32_16x16x32_bf16 v[188:191], v[164:167], v[56:59], v[188:191]
    ds_read_b64_tr_b16 a[100:101], v235 offset:0
    ds_read_b64_tr_b16 a[102:103], v235 offset:1024
    v_mfma_f32_16x16x32_bf16 v[192:195], v[164:167], v[72:75], v[192:195]
    s_waitcnt lgkmcnt(6)
    s_lshl_b32 s101, s70, 4
    s_add_u32 m0, s99, 57344
    s_nop 0
    buffer_load_dwordx4 v230, s[32:35], s101 offen lds
    buffer_load_dwordx4 v231, s[32:35], s101 offen offset:1024 lds
    v_mfma_f32_16x16x32_bf16 v[196:199], v[164:167], v[88:91], v[196:199]
    s_waitcnt vmcnt(19)
    ds_read_b64_tr_b16 a[40:41], v232 offset:16384
    v_mfma_f32_16x16x32_bf16 v[200:203], v[164:167], v[104:107], v[200:203]
    ds_read_b64_tr_b16 a[42:43], v232 offset:17408
    ds_read_b64_tr_b16 a[44:45], v233 offset:16384
    v_mfma_f32_16x16x32_bf16 v[204:207], v[164:167], v[120:123], v[204:207]
    ds_read_b64_tr_b16 a[46:47], v233 offset:17408
    s_waitcnt lgkmcnt(4)
    s_lshl_b32 s101, s71, 4
    s_add_u32 m0, s99, 65536
    s_nop 0
    buffer_load_dwordx4 v230, s[32:35], s101 offen lds
    buffer_load_dwordx4 v231, s[32:35], s101 offen offset:1024 lds
    v_mfma_f32_16x16x32_bf16 v[180:183], v[168:171], v[20:23], v[180:183]
    ds_read_b64 v[148:149], v222 offset:1152
    s_waitcnt vmcnt(19)
    ds_read_b64_tr_b16 a[48:49], v232 offset:24576
    v_mfma_f32_16x16x32_bf16 v[184:187], v[168:171], v[36:39], v[184:187]
    ds_read_b64 v[150:151], v222 offset:1160
    ds_read_b64_tr_b16 a[50:51], v232 offset:25600
    v_mfma_f32_16x16x32_bf16 v[188:191], v[168:171], v[52:55], v[188:191]
    ds_read_b64_tr_b16 a[52:53], v233 offset:24576
    ds_read_b64_tr_b16 a[54:55], v233 offset:25600
    v_mfma_f32_16x16x32_bf16 v[192:195], v[168:171], v[68:71], v[192:195]
    s_waitcnt lgkmcnt(6)
    s_lshl_b32 s101, s80, 4
    s_add_u32 m0, s99, 16384
    s_nop 0
    buffer_load_dwordx4 v230, s[32:35], s101 offen lds
    buffer_load_dwordx4 v231, s[32:35], s101 offen offset:1024 lds
    v_mfma_f32_16x16x32_bf16 v[196:199], v[168:171], v[84:87], v[196:199]
    s_waitcnt vmcnt(19)
    ds_read_b64_tr_b16 a[56:57], v234 offset:8192
    v_mfma_f32_16x16x32_bf16 v[200:203], v[168:171], v[100:103], v[200:203]
    ds_read_b64_tr_b16 a[58:59], v234 offset:9216
    ds_read_b64_tr_b16 a[60:61], v235 offset:8192
    v_mfma_f32_16x16x32_bf16 v[204:207], v[168:171], v[116:119], v[204:207]
    ds_read_b64_tr_b16 a[62:63], v235 offset:9216
    s_waitcnt lgkmcnt(4)
    s_lshl_b32 s101, s73, 4
    s_add_u32 m0, s99, 24576
    s_nop 0
    buffer_load_dwordx4 v230, s[32:35], s101 offen lds
    buffer_load_dwordx4 v231, s[32:35], s101 offen offset:1024 lds
    v_mfma_f32_16x16x32_bf16 v[180:183], v[172:175], v[16:19], v[180:183]
    ds_read_b64 v[152:153], v222 offset:1280
    s_waitcnt vmcnt(19)
    ds_read_b64_tr_b16 a[128:129], v234 offset:16384
    v_mfma_f32_16x16x32_bf16 v[184:187], v[172:175], v[32:35], v[184:187]
    ds_read_b64 v[154:155], v222 offset:1288
    ds_read_b64_tr_b16 a[130:131], v234 offset:17408
    v_mfma_f32_16x16x32_bf16 v[188:191], v[172:175], v[48:51], v[188:191]
    ds_read_b64_tr_b16 a[132:133], v235 offset:16384
    ds_read_b64_tr_b16 a[134:135], v235 offset:17408
    v_mfma_f32_16x16x32_bf16 v[192:195], v[172:175], v[64:67], v[192:195]
    s_waitcnt lgkmcnt(6)
    s_lshl_b32 s101, s74, 4
    s_add_u32 m0, s99, 73728
    s_nop 0
    buffer_load_dwordx4 v230, s[32:35], s101 offen lds
    buffer_load_dwordx4 v231, s[32:35], s101 offen offset:1024 lds
    v_mfma_f32_16x16x32_bf16 v[196:199], v[172:175], v[80:83], v[196:199]
    s_waitcnt vmcnt(19)
    ds_read_b64_tr_b16 a[72:73], v232 offset:32768
    v_mfma_f32_16x16x32_bf16 v[200:203], v[172:175], v[96:99], v[200:203]
    ds_read_b64_tr_b16 a[74:75], v232 offset:33792
    ds_read_b64_tr_b16 a[76:77], v233 offset:32768
    v_mfma_f32_16x16x32_bf16 v[204:207], v[172:175], v[112:115], v[204:207]
    ds_read_b64_tr_b16 a[78:79], v233 offset:33792
    s_waitcnt lgkmcnt(4)
    s_lshl_b32 s101, s75, 4
    s_add_u32 m0, s99, 81920
    s_nop 0
    buffer_load_dwordx4 v230, s[32:35], s101 offen lds
    buffer_load_dwordx4 v231, s[32:35], s101 offen offset:1024 lds
    v_mfma_f32_16x16x32_bf16 v[184:187], v[144:147], v[28:31], v[184:187]
    ds_read_b64 v[156:157], v222 offset:1408
    s_waitcnt vmcnt(19)
    ds_read_b64_tr_b16 a[80:81], v232 offset:40960
    v_mfma_f32_16x16x32_bf16 v[188:191], v[144:147], v[44:47], v[188:191]
    ds_read_b64 v[158:159], v222 offset:1416
    ds_read_b64_tr_b16 a[82:83], v232 offset:41984
    v_mfma_f32_16x16x32_bf16 v[192:195], v[144:147], v[60:63], v[192:195]
    ds_read_b64_tr_b16 a[84:85], v233 offset:40960
    ds_read_b64_tr_b16 a[86:87], v233 offset:41984
    v_mfma_f32_16x16x32_bf16 v[196:199], v[144:147], v[76:79], v[196:199]
    s_waitcnt lgkmcnt(6)
    s_lshl_b32 s101, s77, 4
    s_add_u32 m0, s99, 32768
    s_nop 0
    buffer_load_dwordx4 v230, s[32:35], s101 offen lds
    buffer_load_dwordx4 v231, s[32:35], s101 offen offset:1024 lds
    v_mfma_f32_16x16x32_bf16 v[200:203], v[144:147], v[92:95], v[200:203]
    s_waitcnt vmcnt(19)
    ds_read_b64_tr_b16 a[88:89], v232 offset:0
    v_mfma_f32_16x16x32_bf16 v[204:207], v[144:147], v[108:111], v[204:207]
    ds_read_b64_tr_b16 a[90:91], v232 offset:1024
    ds_read_b64_tr_b16 a[92:93], v233 offset:0
    v_mfma_f32_16x16x32_bf16 v[184:187], v[148:151], v[24:27], v[184:187]
    ds_read_b64 v[160:161], v222 offset:1536
    ds_read_b64_tr_b16 a[94:95], v233 offset:1024
    v_mfma_f32_16x16x32_bf16 v[188:191], v[148:151], v[40:43], v[188:191]
    ds_read_b64 v[162:163], v222 offset:1544
    s_waitcnt lgkmcnt(6)
    s_lshl_b32 s101, s78, 4
    s_add_u32 m0, s99, 40960
    s_nop 0
    buffer_load_dwordx4 v230, s[32:35], s101 offen lds
    buffer_load_dwordx4 v231, s[32:35], s101 offen offset:1024 lds
    v_mfma_f32_16x16x32_bf16 v[192:195], v[148:151], v[56:59], v[192:195]
    s_waitcnt vmcnt(19)
    ds_read_b64_tr_b16 a[160:161], v232 offset:8192
    v_mfma_f32_16x16x32_bf16 v[196:199], v[148:151], v[72:75], v[196:199]
    ds_read_b64_tr_b16 a[162:163], v232 offset:9216
    ds_read_b64_tr_b16 a[164:165], v233 offset:8192
    v_mfma_f32_16x16x32_bf16 v[200:203], v[148:151], v[88:91], v[200:203]
    ds_read_b64_tr_b16 a[166:167], v233 offset:9216
    s_waitcnt lgkmcnt(5)
    s_lshl_b32 s101, s79, 4
    s_add_u32 m0, s99, 0
    s_nop 0
    buffer_load_dwordx4 v230, s[32:35], s101 offen lds
    buffer_load_dwordx4 v231, s[32:35], s101 offen offset:1024 lds
    v_mfma_f32_16x16x32_bf16 v[204:207], v[148:151], v[104:107], v[204:207]
    s_waitcnt vmcnt(19)
    ds_read_b64_tr_b16 a[104:105], v232 offset:49152
    v_mfma_f32_16x16x32_bf16 v[184:187], v[152:155], v[20:23], v[184:187]
    ds_read_b64 v[164:165], v222 offset:1664
    ds_read_b64_tr_b16 a[106:107], v232 offset:50176
    v_mfma_f32_16x16x32_bf16 v[188:191], v[152:155], v[36:39], v[188:191]
    ds_read_b64 v[166:167], v222 offset:1672
    ds_read_b64_tr_b16 a[108:109], v233 offset:49152
    v_mfma_f32_16x16x32_bf16 v[192:195], v[152:155], v[52:55], v[192:195]
    ds_read_b64_tr_b16 a[110:111], v233 offset:50176
    s_waitcnt lgkmcnt(6)
    s_lshl_b32 s101, s81, 4
    s_add_u32 m0, s99, 8192
    s_nop 0
    buffer_load_dwordx4 v230, s[32:35], s101 offen lds
    buffer_load_dwordx4 v231, s[32:35], s101 offen offset:1024 lds
    v_mfma_f32_16x16x32_bf16 v[196:199], v[152:155], v[68:71], v[196:199]
    s_waitcnt vmcnt(18)
    ds_read_b64_tr_b16 a[112:113], v232 offset:57344
    v_mfma_f32_16x16x32_bf16 v[200:203], v[152:155], v[84:87], v[200:203]
    ds_read_b64_tr_b16 a[114:115], v232 offset:58368
    ds_read_b64_tr_b16 a[116:117], v233 offset:57344
    v_mfma_f32_16x16x32_bf16 v[204:207], v[152:155], v[100:103], v[204:207]
    ds_read_b64_tr_b16 a[118:119], v233 offset:58368
    s_waitcnt lgkmcnt(4)
    s_lshl_b32 s101, s82, 4
    s_add_u32 m0, s99, 49152
    s_nop 0
    buffer_load_dwordx4 v230, s[32:35], s101 offen lds
    buffer_load_dwordx4 v231, s[32:35], s101 offen offset:1024 lds
    v_mfma_f32_16x16x32_bf16 v[184:187], v[156:159], v[16:19], v[184:187]
    ds_read_b64 v[168:169], v222 offset:1792
    s_waitcnt vmcnt(18)
    ds_read_b64_tr_b16 a[120:121], v234 offset:0
    v_mfma_f32_16x16x32_bf16 v[188:191], v[156:159], v[32:35], v[188:191]
    ds_read_b64 v[170:171], v222 offset:1800
    ds_read_b64_tr_b16 a[122:123], v234 offset:1024
    v_mfma_f32_16x16x32_bf16 v[192:195], v[156:159], v[48:51], v[192:195]
    ds_read_b64_tr_b16 a[124:125], v235 offset:0
    ds_read_b64_tr_b16 a[126:127], v235 offset:1024
    v_mfma_f32_16x16x32_bf16 v[196:199], v[156:159], v[64:67], v[196:199]
    s_waitcnt lgkmcnt(6)
    s_lshl_b32 s101, s83, 4
    s_add_u32 m0, s99, 57344
    s_nop 0
    buffer_load_dwordx4 v230, s[32:35], s101 offen lds
    buffer_load_dwordx4 v231, s[32:35], s101 offen offset:1024 lds
    v_mfma_f32_16x16x32_bf16 v[200:203], v[156:159], v[80:83], v[200:203]
    v_mfma_f32_16x16x32_bf16 v[204:207], v[156:159], v[96:99], v[204:207]
    s_waitcnt vmcnt(18)
    ds_read_b64_tr_b16 a[192:193], v232 offset:16384
    v_mfma_f32_16x16x32_bf16 v[188:191], v[160:163], v[28:31], v[188:191]
    ds_read_b64 v[172:173], v222 offset:1920
    ds_read_b64_tr_b16 a[194:195], v232 offset:17408
    v_mfma_f32_16x16x32_bf16 v[192:195], v[160:163], v[44:47], v[192:195]
    ds_read_b64 v[174:175], v222 offset:1928
    ds_read_b64_tr_b16 a[196:197], v233 offset:16384
    v_mfma_f32_16x16x32_bf16 v[196:199], v[160:163], v[60:63], v[196:199]
    ds_read_b64_tr_b16 a[198:199], v233 offset:17408
    v_mfma_f32_16x16x32_bf16 v[200:203], v[160:163], v[76:79], v[200:203]
    s_waitcnt vmcnt(16)
    ds_read_b64_tr_b16 a[136:137], v232 offset:24576
    v_mfma_f32_16x16x32_bf16 v[204:207], v[160:163], v[92:95], v[204:207]
    ds_read_b64_tr_b16 a[138:139], v232 offset:25600
    ds_read_b64_tr_b16 a[140:141], v233 offset:24576
    v_mfma_f32_16x16x32_bf16 v[188:191], v[164:167], v[24:27], v[188:191]
    ds_read_b64 v[144:145], v222 offset:2048
    ds_read_b64_tr_b16 a[142:143], v233 offset:25600
    v_mfma_f32_16x16x32_bf16 v[192:195], v[164:167], v[40:43], v[192:195]
    ds_read_b64 v[146:147], v222 offset:2056
    v_mfma_f32_16x16x32_bf16 v[196:199], v[164:167], v[56:59], v[196:199]
    v_mfma_f32_16x16x32_bf16 v[200:203], v[164:167], v[72:75], v[200:203]
    s_waitcnt vmcnt(14)
    ds_read_b64_tr_b16 a[144:145], v234 offset:8192
    v_mfma_f32_16x16x32_bf16 v[204:207], v[164:167], v[88:91], v[204:207]
    ds_read_b64_tr_b16 a[146:147], v234 offset:9216
    ds_read_b64_tr_b16 a[148:149], v235 offset:8192
    s_waitcnt lgkmcnt(15)
    v_mfma_f32_16x16x32_bf16 v[188:191], v[168:171], v[20:23], v[188:191]
    ds_read_b64 v[148:149], v222 offset:2176
    ds_read_b64_tr_b16 a[150:151], v235 offset:9216
    v_mfma_f32_16x16x32_bf16 v[192:195], v[168:171], v[36:39], v[192:195]
    ds_read_b64 v[150:151], v222 offset:2184
    v_mfma_f32_16x16x32_bf16 v[196:199], v[168:171], v[52:55], v[196:199]
    s_waitcnt vmcnt(12)
    ds_read_b64_tr_b16 a[152:153], v234 offset:16384
    v_mfma_f32_16x16x32_bf16 v[200:203], v[168:171], v[68:71], v[200:203]
    ds_read_b64_tr_b16 a[154:155], v234 offset:17408
    ds_read_b64_tr_b16 a[156:157], v235 offset:16384
    v_mfma_f32_16x16x32_bf16 v[204:207], v[168:171], v[84:87], v[204:207]
    ds_read_b64_tr_b16 a[158:159], v235 offset:17408
    s_waitcnt lgkmcnt(15)
    v_mfma_f32_16x16x32_bf16 v[188:191], v[172:175], v[16:19], v[188:191]
    ds_read_b64 v[152:153], v222 offset:2304
    v_mfma_f32_16x16x32_bf16 v[192:195], v[172:175], v[32:35], v[192:195]
    ds_read_b64 v[154:155], v222 offset:2312
    v_mfma_f32_16x16x32_bf16 v[196:199], v[172:175], v[48:51], v[196:199]
    s_waitcnt vmcnt(10)
    ds_read_b64_tr_b16 a[168:169], v232 offset:32768
    v_mfma_f32_16x16x32_bf16 v[200:203], v[172:175], v[64:67], v[200:203]
    ds_read_b64_tr_b16 a[170:171], v232 offset:33792
    ds_read_b64_tr_b16 a[172:173], v233 offset:32768
    v_mfma_f32_16x16x32_bf16 v[204:207], v[172:175], v[80:83], v[204:207]
    ds_read_b64_tr_b16 a[174:175], v233 offset:33792
    s_waitcnt lgkmcnt(15)
    v_mfma_f32_16x16x32_bf16 v[192:195], v[144:147], v[28:31], v[192:195]
    ds_read_b64 v[156:157], v222 offset:2432
    v_mfma_f32_16x16x32_bf16 v[196:199], v[144:147], v[44:47], v[196:199]
    ds_read_b64 v[158:159], v222 offset:2440
    s_lshl_b32 s91, s94, 11
    s_lshl_b32 s90, s4, 8
    s_add_u32 s91, s91, s90
    s_add_u32 s91, s91, 13697024
    v_bfe_u32 v6, v0, 2, 1
    v_lshlrev_b32 v6, 10, v6
    v_and_b32 v7, 3, v0
    v_lshl_add_u32 v6, v7, 6, v6
    buffer_load_dwordx2 v[4:5], v6, s[44:47], s91 offen sc1
    v_mfma_f32_16x16x32_bf16 v[200:203], v[144:147], v[60:63], v[200:203]
    s_waitcnt vmcnt(9)
    ds_read_b64_tr_b16 a[176:177], v232 offset:40960
    v_mfma_f32_16x16x32_bf16 v[204:207], v[144:147], v[76:79], v[204:207]
    ds_read_b64_tr_b16 a[178:179], v232 offset:41984
    ds_read_b64_tr_b16 a[180:181], v233 offset:40960
    s_waitcnt lgkmcnt(15)
    v_mfma_f32_16x16x32_bf16 v[192:195], v[148:151], v[24:27], v[192:195]
    ds_read_b64 v[160:161], v222 offset:2560
    ds_read_b64_tr_b16 a[182:183], v233 offset:41984
    v_mfma_f32_16x16x32_bf16 v[196:199], v[148:151], v[40:43], v[196:199]
    ds_read_b64 v[162:163], v222 offset:2568
    v_mfma_f32_16x16x32_bf16 v[200:203], v[148:151], v[56:59], v[200:203]
    s_waitcnt vmcnt(7)
    ds_read_b64_tr_b16 a[184:185], v232 offset:0
    v_mfma_f32_16x16x32_bf16 v[204:207], v[148:151], v[72:75], v[204:207]
    ds_read_b64_tr_b16 a[186:187], v232 offset:1024
    ds_read_b64_tr_b16 a[188:189], v233 offset:0
    s_waitcnt lgkmcnt(15)
    v_mfma_f32_16x16x32_bf16 v[192:195], v[152:155], v[20:23], v[192:195]
    ds_read_b64 v[164:165], v222 offset:2688
    ds_read_b64_tr_b16 a[190:191], v233 offset:1024
    v_mfma_f32_16x16x32_bf16 v[196:199], v[152:155], v[36:39], v[196:199]
    ds_read_b64 v[166:167], v222 offset:2696
    v_mfma_f32_16x16x32_bf16 v[200:203], v[152:155], v[52:55], v[200:203]
    s_waitcnt vmcnt(5)
    ds_read_b64_tr_b16 a[200:201], v232 offset:8192
    v_mfma_f32_16x16x32_bf16 v[204:207], v[152:155], v[68:71], v[204:207]
    ds_read_b64_tr_b16 a[202:203], v232 offset:9216
    ds_read_b64_tr_b16 a[204:205], v233 offset:8192
    s_waitcnt lgkmcnt(15)
    v_mfma_f32_16x16x32_bf16 v[192:195], v[156:159], v[16:19], v[192:195]
    ds_read_b64 v[168:169], v222 offset:2816
    ds_read_b64_tr_b16 a[206:207], v233 offset:9216
    v_mfma_f32_16x16x32_bf16 v[196:199], v[156:159], v[32:35], v[196:199]
    ds_read_b64 v[170:171], v222 offset:2824
    v_mfma_f32_16x16x32_bf16 v[200:203], v[156:159], v[48:51], v[200:203]
    v_mfma_f32_16x16x32_bf16 v[204:207], v[156:159], v[64:67], v[204:207]
    s_waitcnt vmcnt(3)
    ds_read_b64_tr_b16 a[208:209], v232 offset:49152
    s_waitcnt lgkmcnt(13)
    v_mfma_f32_16x16x32_bf16 v[196:199], v[160:163], v[28:31], v[196:199]
    ds_read_b64 v[172:173], v222 offset:2944
    ds_read_b64_tr_b16 a[210:211], v232 offset:50176
    v_mfma_f32_16x16x32_bf16 v[200:203], v[160:163], v[44:47], v[200:203]
    ds_read_b64 v[174:175], v222 offset:2952
    ds_read_b64_tr_b16 a[212:213], v233 offset:49152
    v_mfma_f32_16x16x32_bf16 v[204:207], v[160:163], v[60:63], v[204:207]
    ds_read_b64_tr_b16 a[214:215], v233 offset:50176
    s_waitcnt lgkmcnt(12)
    v_mfma_f32_16x16x32_bf16 v[196:199], v[164:167], v[24:27], v[196:199]
    ds_read_b64 v[144:145], v222 offset:3072
    s_waitcnt vmcnt(1)
    ds_read_b64_tr_b16 a[216:217], v232 offset:57344
    v_mfma_f32_16x16x32_bf16 v[200:203], v[164:167], v[40:43], v[200:203]
    ds_read_b64 v[146:147], v222 offset:3080
    ds_read_b64_tr_b16 a[218:219], v232 offset:58368
    v_mfma_f32_16x16x32_bf16 v[204:207], v[164:167], v[56:59], v[204:207]
    ds_read_b64_tr_b16 a[220:221], v233 offset:57344
    ds_read_b64_tr_b16 a[222:223], v233 offset:58368
    s_waitcnt lgkmcnt(12)
    v_mfma_f32_16x16x32_bf16 v[196:199], v[168:171], v[20:23], v[196:199]
    ds_read_b64 v[148:149], v222 offset:3200
    v_mfma_f32_16x16x32_bf16 v[200:203], v[168:171], v[36:39], v[200:203]
    ds_read_b64 v[150:151], v222 offset:3208
    v_mfma_f32_16x16x32_bf16 v[204:207], v[168:171], v[52:55], v[204:207]
    s_waitcnt lgkmcnt(10)
    v_mfma_f32_16x16x32_bf16 v[196:199], v[172:175], v[16:19], v[196:199]
    ds_read_b64 v[152:153], v222 offset:3328
    v_mfma_f32_16x16x32_bf16 v[200:203], v[172:175], v[32:35], v[200:203]
    ds_read_b64 v[154:155], v222 offset:3336
    v_mfma_f32_16x16x32_bf16 v[204:207], v[172:175], v[48:51], v[204:207]
    s_waitcnt lgkmcnt(7)
    v_mfma_f32_16x16x32_bf16 v[200:203], v[144:147], v[28:31], v[200:203]
    ds_read_b64 v[156:157], v222 offset:3456
    v_mfma_f32_16x16x32_bf16 v[204:207], v[144:147], v[44:47], v[204:207]
    ds_read_b64 v[158:159], v222 offset:3464
    s_waitcnt lgkmcnt(4)
    v_mfma_f32_16x16x32_bf16 v[200:203], v[148:151], v[24:27], v[200:203]
    ds_read_b64 v[160:161], v222 offset:3584
    v_mfma_f32_16x16x32_bf16 v[204:207], v[148:151], v[40:43], v[204:207]
    ds_read_b64 v[162:163], v222 offset:3592
    s_waitcnt lgkmcnt(4)
    v_mfma_f32_16x16x32_bf16 v[200:203], v[152:155], v[20:23], v[200:203]
    ds_read_b64 v[164:165], v222 offset:3712
    v_mfma_f32_16x16x32_bf16 v[204:207], v[152:155], v[36:39], v[204:207]
    ds_read_b64 v[166:167], v222 offset:3720
    s_waitcnt lgkmcnt(4)
    v_mfma_f32_16x16x32_bf16 v[200:203], v[156:159], v[16:19], v[200:203]
    ds_read_b64 v[168:169], v222 offset:3840
    v_mfma_f32_16x16x32_bf16 v[204:207], v[156:159], v[32:35], v[204:207]
    ds_read_b64 v[170:171], v222 offset:3848
    s_waitcnt lgkmcnt(4)
    v_mfma_f32_16x16x32_bf16 v[204:207], v[160:163], v[28:31], v[204:207]
    ds_read_b64 v[172:173], v222 offset:3968
    ds_read_b64 v[174:175], v222 offset:3976
    s_waitcnt lgkmcnt(4)
    v_mfma_f32_16x16x32_bf16 v[204:207], v[164:167], v[24:27], v[204:207]
    s_waitcnt lgkmcnt(2)
    v_mfma_f32_16x16x32_bf16 v[204:207], v[168:171], v[20:23], v[204:207]
    s_waitcnt lgkmcnt(0)
    v_mfma_f32_16x16x32_bf16 v[204:207], v[172:175], v[16:19], v[204:207]
    s_waitcnt vmcnt(0)
    v_cmp_ne_u64 vcc, v[2:3], v[4:5]
    s_cbranch_vccz L_ok_f2_5
    s_mov_b32 s1, 0
L_spin_f2_6:
    s_sleep 1
    buffer_load_dwordx2 v[4:5], v6, s[44:47], s91 offen sc1
    s_waitcnt vmcnt(0)
    v_cmp_ne_u64 vcc, v[2:3], v[4:5]
    s_cbranch_vccz L_ok_f2_5
    s_add_u32 s1, s1, 1
    s_cmp_lt_u32 s1, 0x10000
    s_cbranch_scc1 L_spin_f2_6
L_ok_f2_5:
    buffer_load_dwordx4 a[224:227], v236, s[44:47], s56 offen sc1
    buffer_load_dwordx4 a[228:231], v237, s[44:47], s56 offen sc1
    buffer_load_dwordx4 a[232:235], v236, s[44:47], s57 offen sc1
    buffer_load_dwordx4 a[236:239], v237, s[44:47], s57 offen sc1
    buffer_load_dwordx4 a[240:243], v236, s[44:47], s60 offen sc1
    buffer_load_dwordx4 a[244:247], v237, s[44:47], s60 offen sc1
    buffer_load_dwordx4 a[248:251], v236, s[44:47], s64 offen sc1
    buffer_load_dwordx4 a[252:255], v237, s[44:47], s64 offen sc1
    ds_read_b64 v[32:33], v224 offset:0
    ds_read_b64 v[34:35], v224 offset:512
    ds_read_b64 v[36:37], v224 offset:1024
    ds_read_b64 v[38:39], v224 offset:1536
    s_cmp_lg_u32 s53, 0
    s_cbranch_scc1 L_cvp1_7
    ds_write_b128 v227, v[192:195] offset:0
    ds_write_b128 v227, v[196:199] offset:1024
    ds_write_b128 v227, v[200:203] offset:2048
    ds_write_b128 v227, v[204:207] offset:3072
    s_branch L_cvp2_8
L_cvp1_7:
    ds_write_b128 v227, v[176:179] offset:0
    ds_write_b128 v227, v[180:183] offset:1024
    ds_write_b128 v227, v[184:187] offset:2048
    ds_write_b128 v227, v[188:191] offset:3072
    v_mov_b32 v176, v192
    v_mov_b32 v177, v193
    v_mov_b32 v178, v194
    v_mov_b32 v179, v195
    v_mov_b32 v180, v196
    v_mov_b32 v181, v197
    v_mov_b32 v182, v198
    v_mov_b32 v183, v199
    v_mov_b32 v184, v200
    v_mov_b32 v185, v201
    v_mov_b32 v186, v202
    v_mov_b32 v187, v203
    v_mov_b32 v188, v204
    v_mov_b32 v189, v205
    v_mov_b32 v190, v206
    v_mov_b32 v191, v207
L_cvp2_8:
    s_waitcnt lgkmcnt(4)
    v_and_b32 v40, 0xffff0000, v33
    v_lshlrev_b32 v41, 16, v33
    v_and_b32 v42, 0xffff0000, v32
    v_lshlrev_b32 v43, 16, v32
    v_and_b32 v44, 0xffff0000, v35
    v_lshlrev_b32 v45, 16, v35
    v_and_b32 v46, 0xffff0000, v34
    v_lshlrev_b32 v47, 16, v34
    v_and_b32 v48, 0xffff0000, v37
    v_lshlrev_b32 v49, 16, v37
    v_and_b32 v50, 0xffff0000, v36
    v_lshlrev_b32 v51, 16, v36
    v_and_b32 v52, 0xffff0000, v39
    v_lshlrev_b32 v53, 16, v39
    v_and_b32 v54, 0xffff0000, v38
    v_lshlrev_b32 v55, 16, v38
    v_lshlrev_b32 v249, 16, v249
    v_fmac_f32 v176, v249, v40
    v_fmac_f32 v177, v249, v41
    v_fmac_f32 v178, v249, v42
    v_fmac_f32 v179, v249, v43
    v_fmac_f32 v180, v249, v44
    v_fmac_f32 v181, v249, v45
    v_fmac_f32 v182, v249, v46
    v_fmac_f32 v183, v249, v47
    v_fmac_f32 v184, v249, v48
    v_fmac_f32 v185, v249, v49
    v_fmac_f32 v186, v249, v50
    v_fmac_f32 v187, v249, v51
    v_fmac_f32 v188, v249, v52
    v_fmac_f32 v189, v249, v53
    v_fmac_f32 v190, v249, v54
    v_fmac_f32 v191, v249, v55
    s_waitcnt lgkmcnt(0)
    s_barrier
    ds_read_b128 v[16:19], v228 offset:0
    ds_read_b128 v[20:23], v228 offset:1024
    ds_read_b128 v[24:27], v228 offset:2048
    ds_read_b128 v[28:31], v228 offset:3072
    s_waitcnt lgkmcnt(3)
    v_pk_add_f32 v[176:177], v[176:177], v[16:17]
    v_pk_add_f32 v[178:179], v[178:179], v[18:19]
    s_waitcnt lgkmcnt(2)
    v_pk_add_f32 v[180:181], v[180:181], v[20:21]
    v_pk_add_f32 v[182:183], v[182:183], v[22:23]
    s_waitcnt lgkmcnt(1)
    v_pk_add_f32 v[184:185], v[184:185], v[24:25]
    v_pk_add_f32 v[186:187], v[186:187], v[26:27]
    s_waitcnt lgkmcnt(0)
    v_pk_add_f32 v[188:189], v[188:189], v[28:29]
    v_pk_add_f32 v[190:191], v[190:191], v[30:31]
    v_cvt_pk_bf16_f32 v40, v176, v177
    v_cvt_pk_bf16_f32 v41, v178, v179
    v_cvt_pk_bf16_f32 v42, v180, v181
    v_cvt_pk_bf16_f32 v43, v182, v183
    v_cvt_pk_bf16_f32 v44, v184, v185
    v_cvt_pk_bf16_f32 v45, v186, v187
    v_cvt_pk_bf16_f32 v46, v188, v189
    v_cvt_pk_bf16_f32 v47, v190, v191
    v_permlane16_swap_b32 v40, v42
    v_permlane16_swap_b32 v41, v43
    buffer_store_dwordx4 v[40:43], v229, s[44:47], 0 offen offset:0 sc1
    v_permlane16_swap_b32 v44, v46
    v_permlane16_swap_b32 v45, v47
    buffer_store_dwordx4 v[44:47], v229, s[44:47], 0 offen offset:1024 sc1
    s_waitcnt vmcnt(9)
    v_mfma_f32_32x32x16_bf16 v[16:31], a[0:3], a[224:227], 0
    buffer_load_dwordx4 v[208:211], v236, s[44:47], s68 offen sc1
    buffer_load_dwordx4 v[212:215], v237, s[44:47], s68 offen sc1
    buffer_load_dwordx4 v[80:83], v236, s[44:47], s72 offen sc1
    buffer_load_dwordx4 v[84:87], v237, s[44:47], s72 offen sc1
    s_waitcnt vmcnt(12)
    v_mfma_f32_32x32x16_bf16 v[32:47], a[0:3], a[228:231], 0
    v_mfma_f32_32x32x16_bf16 v[48:63], a[4:7], a[224:227], 0
    v_mfma_f32_32x32x16_bf16 v[64:79], a[4:7], a[228:231], 0
    s_waitcnt vmcnt(11)
    v_mfma_f32_32x32x16_bf16 v[16:31], a[8:11], a[232:235], v[16:31]
    buffer_load_dwordx4 v[88:91], v236, s[44:47], s76 offen sc1
    buffer_load_dwordx4 v[92:95], v237, s[44:47], s76 offen sc1
    s_waitcnt vmcnt(12)
    v_mfma_f32_32x32x16_bf16 v[32:47], a[8:11], a[236:239], v[32:47]
    v_mfma_f32_32x32x16_bf16 v[48:63], a[12:15], a[232:235], v[48:63]
    v_mfma_f32_32x32x16_bf16 v[64:79], a[12:15], a[236:239], v[64:79]
    s_waitcnt vmcnt(11)
    v_mfma_f32_32x32x16_bf16 v[16:31], a[32:35], a[240:243], v[16:31]
    buffer_load_dwordx4 v[96:99], v236, s[44:47], s80 offen sc1
    buffer_load_dwordx4 v[100:103], v237, s[44:47], s80 offen sc1
    s_waitcnt vmcnt(12)
    v_mfma_f32_32x32x16_bf16 v[32:47], a[32:35], a[244:247], v[32:47]
    v_mfma_f32_32x32x16_bf16 v[48:63], a[36:39], a[240:243], v[48:63]
    v_mfma_f32_32x32x16_bf16 v[64:79], a[36:39], a[244:247], v[64:79]
    s_waitcnt vmcnt(11)
    v_mfma_f32_32x32x16_bf16 v[16:31], a[64:67], a[248:251], v[16:31]
    buffer_load_dwordx4 v[104:107], v236, s[44:47], s58 offen sc1
    buffer_load_dwordx4 v[108:111], v237, s[44:47], s58 offen sc1
    s_waitcnt vmcnt(12)
    v_mfma_f32_32x32x16_bf16 v[32:47], a[64:67], a[252:255], v[32:47]
    v_mfma_f32_32x32x16_bf16 v[48:63], a[68:71], a[248:251], v[48:63]
    v_mfma_f32_32x32x16_bf16 v[64:79], a[68:71], a[252:255], v[64:79]
    s_waitcnt vmcnt(9)
    v_mfma_f32_32x32x16_bf16 v[16:31], a[96:99], v[208:211], v[16:31]
    buffer_load_dwordx4 v[112:115], v236, s[44:47], s61 offen sc1
    buffer_load_dwordx4 v[116:119], v237, s[44:47], s61 offen sc1
    s_waitcnt vmcnt(10)
    v_mfma_f32_32x32x16_bf16 v[32:47], a[96:99], v[212:215], v[32:47]
    v_mfma_f32_32x32x16_bf16 v[48:63], a[100:103], v[208:211], v[48:63]
    v_mfma_f32_32x32x16_bf16 v[64:79], a[100:103], v[212:215], v[64:79]
    s_waitcnt vmcnt(9)
    v_mfma_f32_32x32x16_bf16 v[16:31], a[128:131], v[80:83], v[16:31]
    buffer_load_dwordx4 v[120:123], v236, s[44:47], s65 offen sc1
    buffer_load_dwordx4 v[124:127], v237, s[44:47], s65 offen sc1
    s_waitcnt vmcnt(10)
    v_mfma_f32_32x32x16_bf16 v[32:47], a[128:131], v[84:87], v[32:47]
    v_mfma_f32_32x32x16_bf16 v[48:63], a[132:135], v[80:83], v[48:63]
    v_mfma_f32_32x32x16_bf16 v[64:79], a[132:135], v[84:87], v[64:79]
    s_waitcnt vmcnt(9)
    v_mfma_f32_32x32x16_bf16 v[16:31], a[160:163], v[88:91], v[16:31]
    buffer_load_dwordx4 v[128:131], v236, s[44:47], s69 offen sc1
    buffer_load_dwordx4 v[132:135], v237, s[44:47], s69 offen sc1
    s_waitcnt vmcnt(10)
    v_mfma_f32_32x32x16_bf16 v[32:47], a[160:163], v[92:95], v[32:47]
    v_mfma_f32_32x32x16_bf16 v[48:63], a[164:167], v[88:91], v[48:63]
    v_mfma_f32_32x32x16_bf16 v[64:79], a[164:167], v[92:95], v[64:79]
    s_waitcnt vmcnt(9)
    v_mfma_f32_32x32x16_bf16 v[16:31], a[192:195], v[96:99], v[16:31]
    buffer_load_dwordx4 v[136:139], v236, s[44:47], s73 offen sc1
    buffer_load_dwordx4 v[140:143], v237, s[44:47], s73 offen sc1
    s_waitcnt vmcnt(10)
    v_mfma_f32_32x32x16_bf16 v[32:47], a[192:195], v[100:103], v[32:47]
    v_mfma_f32_32x32x16_bf16 v[48:63], a[196:199], v[96:99], v[48:63]
    v_mfma_f32_32x32x16_bf16 v[64:79], a[196:199], v[100:103], v[64:79]
    s_waitcnt vmcnt(9)
    v_mfma_f32_32x32x16_bf16 v[16:31], a[16:19], v[104:107], v[16:31]
    buffer_load_dwordx4 v[144:147], v236, s[44:47], s77 offen sc1
    buffer_load_dwordx4 v[148:151], v237, s[44:47], s77 offen sc1
    s_waitcnt vmcnt(10)
    v_mfma_f32_32x32x16_bf16 v[32:47], a[16:19], v[108:111], v[32:47]
    v_mfma_f32_32x32x16_bf16 v[48:63], a[20:23], v[104:107], v[48:63]
    v_mfma_f32_32x32x16_bf16 v[64:79], a[20:23], v[108:111], v[64:79]
    s_waitcnt vmcnt(9)
    v_mfma_f32_32x32x16_bf16 v[16:31], a[40:43], v[112:115], v[16:31]
    buffer_load_dwordx4 v[152:155], v236, s[44:47], s81 offen sc1
    buffer_load_dwordx4 v[156:159], v237, s[44:47], s81 offen sc1
    s_lshl_b32 s90, s5, 1
    s_add_u32 s90, s90, s53
    s_lshl_b32 s90, s90, 5
    s_add_u32 s90, s90, s6
    s_lshl_b32 s90, s90, 1
    s_lshr_b32 s91, s4, 1
    s_add_u32 s90, s90, s91
    s_lshl_b32 s90, s90, 6
    s_add_u32 s90, s90, 13762560
    s_mov_b64 exec, 1
    buffer_store_dwordx2 v[2:3], off, s[44:47], s90 sc1
    s_mov_b64 exec, -1
    s_waitcnt vmcnt(11)
    v_mfma_f32_32x32x16_bf16 v[32:47], a[40:43], v[116:119], v[32:47]
    s_xor_b32 s96, s4, 1
    s_lshl_b32 s96, s96, 12
    s_add_u32 s96, s96, 90624
    s_lshr_b32 s97, s4, 1
    v_lshrrev_b32 v10, 2, v0
    v_mfma_f32_32x32x16_bf16 v[48:63], a[44:47], v[112:115], v[48:63]
    v_and_b32 v11, 3, v0
    v_lshlrev_b32 v238, 10, v10
    v_lshl_add_u32 v238, v11, 4, v238
    s_lshl_b32 s90, s94, 1
    s_add_u32 s90, s90, s53
    v_mfma_f32_32x32x16_bf16 v[64:79], a[44:47], v[116:119], v[64:79]
    s_lshl_b32 s90, s90, 15
    s_lshl_b32 s91, s95, 7
    s_add_u32 s90, s90, s91
    s_lshl_b32 s91, s97, 6
    s_add_u32 s90, s90, s91
    s_waitcnt vmcnt(10)
    v_mfma_f32_32x32x16_bf16 v[16:31], a[72:75], v[120:123], v[16:31]
    buffer_load_dwordx4 v[160:163], v236, s[44:47], s59 offen sc1
    buffer_load_dwordx4 v[164:167], v237, s[44:47], s59 offen sc1
    v_add_u32 v246, s90, v238
    v_add_u32 v238, 4096, v246
    v_lshlrev_b32 v239, 12, v10
    s_waitcnt vmcnt(11)
    v_mfma_f32_32x32x16_bf16 v[32:47], a[72:75], v[124:127], v[32:47]
    v_lshrrev_b32 v12, 1, v11
    v_lshl_add_u32 v239, v12, 6, v239
    v_and_b32 v12, 1, v0
    v_lshl_add_u32 v239, v12, 4, v239
    s_lshl_b32 s90, s95, 1
    v_mfma_f32_32x32x16_bf16 v[48:63], a[76:79], v[120:123], v[48:63]
    s_add_u32 s90, s90, s97
    s_lshl_b32 s90, s90, 17
    s_lshl_b32 s91, s94, 7
    s_add_u32 s90, s90, s91
    s_lshl_b32 s91, s53, 5
    v_mfma_f32_32x32x16_bf16 v[64:79], a[76:79], v[124:127], v[64:79]
    s_add_u32 s90, s90, s91
    s_add_u32 s90, s90, 2097152
    v_add_u32 v239, s90, v239
    v_mul_u32_u24 v245, 80, v10
    v_lshl_add_u32 v245, v11, 4, v245
    s_waitcnt vmcnt(10)
    v_mfma_f32_32x32x16_bf16 v[16:31], a[104:107], v[128:131], v[16:31]
    buffer_load_dwordx4 v[168:171], v236, s[44:47], s62 offen sc1
    buffer_load_dwordx4 v[172:175], v237, s[44:47], s62 offen sc1
    v_add_u32 v245, s96, v245
    v_and_b32 v10, 31, v0
    v_lshrrev_b32 v11, 5, v0
    s_waitcnt vmcnt(11)
    v_mfma_f32_32x32x16_bf16 v[32:47], a[104:107], v[132:135], v[32:47]
    v_lshlrev_b32 v240, 6, v10
    v_lshl_add_u32 v240, v11, 3, v240
    v_add_u32 v240, s96, v240
    v_mul_u32_u24 v244, 80, v10
    v_lshl_add_u32 v244, v11, 3, v244
    v_mfma_f32_32x32x16_bf16 v[48:63], a[108:111], v[128:131], v[48:63]
    v_add_u32 v244, s96, v244
    v_lshlrev_b32 v247, 3, v10
    v_bfe_u32 v12, v0, 2, 2
    v_lshl_add_u32 v11, v11, 2, v12
    v_lshlrev_b32 v241, 6, v11
    v_mfma_f32_32x32x16_bf16 v[64:79], a[108:111], v[132:135], v[64:79]
    v_bfe_u32 v12, v0, 1, 1
    v_lshl_add_u32 v241, v12, 5, v241
    v_bfe_u32 v12, v0, 4, 1
    v_lshl_add_u32 v241, v12, 4, v241
    v_and_b32 v12, 1, v0
    s_waitcnt vmcnt(10)
    v_mfma_f32_32x32x16_bf16 v[16:31], a[136:139], v[136:139], v[16:31]
    buffer_load_dwordx4 v[176:179], v236, s[44:47], s66 offen sc1
    buffer_load_dwordx4 v[180:183], v237, s[44:47], s66 offen sc1
    v_lshl_add_u32 v241, v12, 3, v241
    v_add_u32 v241, s96, v241
    v_add_u32 v241, 2048, v241
    s_waitcnt vmcnt(11)
    v_mfma_f32_32x32x16_bf16 v[32:47], a[136:139], v[140:143], v[32:47]
    s_lshl_b32 s90, s4, 12
    s_add_u32 s90, s90, 107008
    v_add_u32 v243, s90, v1
    v_mfma_f32_32x32x16_bf16 v[48:63], a[140:143], v[136:139], v[48:63]
    s_mov_b32 m0, s96
    s_nop 0
    buffer_load_dwordx4 v238, s[8:11], 0 offen lds
    v_add_u32 v10, 15360, v238
    buffer_load_dwordx4 v10, s[8:11], 0 offen offset:1024 lds
    v_mfma_f32_32x32x16_bf16 v[64:79], a[140:143], v[140:143], v[64:79]
    s_waitcnt vmcnt(12)
    v_mfma_f32_32x32x16_bf16 v[16:31], a[168:171], v[144:147], v[16:31]
    buffer_load_dwordx4 v[184:187], v236, s[44:47], s70 offen sc1
    buffer_load_dwordx4 v[188:191], v237, s[44:47], s70 offen sc1
    s_waitcnt vmcnt(13)
    v_mfma_f32_32x32x16_bf16 v[32:47], a[168:171], v[148:151], v[32:47]
    v_mfma_f32_32x32x16_bf16 v[48:63], a[172:175], v[144:147], v[48:63]
    v_mfma_f32_32x32x16_bf16 v[64:79], a[172:175], v[148:151], v[64:79]
    s_waitcnt vmcnt(12)
    v_mfma_f32_32x32x16_bf16 v[16:31], a[200:203], v[152:155], v[16:31]
    buffer_load_dwordx4 v[192:195], v236, s[44:47], s74 offen sc1
    buffer_load_dwordx4 v[196:199], v237, s[44:47], s74 offen sc1
    s_waitcnt vmcnt(13)
    v_mfma_f32_32x32x16_bf16 v[32:47], a[200:203], v[156:159], v[32:47]
    v_mfma_f32_32x32x16_bf16 v[48:63], a[204:207], v[152:155], v[48:63]
    v_mfma_f32_32x32x16_bf16 v[64:79], a[204:207], v[156:159], v[64:79]
    s_waitcnt vmcnt(11)
    v_mfma_f32_32x32x16_bf16 v[16:31], a[24:27], v[160:163], v[16:31]
    buffer_load_dwordx4 v[200:203], v236, s[44:47], s78 offen sc1
    buffer_load_dwordx4 v[204:207], v237, s[44:47], s78 offen sc1
    s_waitcnt vmcnt(12)
    v_mfma_f32_32x32x16_bf16 v[32:47], a[24:27], v[164:167], v[32:47]
    v_mfma_f32_32x32x16_bf16 v[48:63], a[28:31], v[160:163], v[48:63]
    v_mfma_f32_32x32x16_bf16 v[64:79], a[28:31], v[164:167], v[64:79]
    s_waitcnt vmcnt(11)
    v_mfma_f32_32x32x16_bf16 v[16:31], a[48:51], v[168:171], v[16:31]
    buffer_load_dwordx4 a[224:227], v236, s[44:47], s82 offen sc1
    buffer_load_dwordx4 a[228:231], v237, s[44:47], s82 offen sc1
    s_waitcnt vmcnt(12)
    v_mfma_f32_32x32x16_bf16 v[32:47], a[48:51], v[172:175], v[32:47]
    v_mfma_f32_32x32x16_bf16 v[48:63], a[52:55], v[168:171], v[48:63]
    v_mfma_f32_32x32x16_bf16 v[64:79], a[52:55], v[172:175], v[64:79]
    s_waitcnt vmcnt(11)
    v_mfma_f32_32x32x16_bf16 v[16:31], a[80:83], v[176:179], v[16:31]
    buffer_load_dwordx4 a[232:235], v236, s[44:47], s63 offen sc1
    buffer_load_dwordx4 a[236:239], v237, s[44:47], s63 offen sc1
    s_waitcnt vmcnt(12)
    v_mfma_f32_32x32x16_bf16 v[32:47], a[80:83], v[180:183], v[32:47]
    v_mfma_f32_32x32x16_bf16 v[48:63], a[84:87], v[176:179], v[48:63]
    v_mfma_f32_32x32x16_bf16 v[64:79], a[84:87], v[180:183], v[64:79]
    s_waitcnt vmcnt(9)
    v_mfma_f32_32x32x16_bf16 v[16:31], a[112:115], v[184:187], v[16:31]
    buffer_load_dwordx4 a[240:243], v236, s[44:47], s67 offen sc1
    buffer_load_dwordx4 a[244:247], v237, s[44:47], s67 offen sc1
    s_waitcnt vmcnt(10)
    v_mfma_f32_32x32x16_bf16 v[32:47], a[112:115], v[188:191], v[32:47]
    v_mfma_f32_32x32x16_bf16 v[48:63], a[116:119], v[184:187], v[48:63]
    v_mfma_f32_32x32x16_bf16 v[64:79], a[116:119], v[188:191], v[64:79]
    s_waitcnt vmcnt(9)
    v_mfma_f32_32x32x16_bf16 v[16:31], a[144:147], v[192:195], v[16:31]
    buffer_load_dwordx4 a[248:251], v236, s[44:47], s71 offen sc1
    buffer_load_dwordx4 a[252:255], v237, s[44:47], s71 offen sc1
    s_waitcnt vmcnt(10)
    v_mfma_f32_32x32x16_bf16 v[32:47], a[144:147], v[196:199], v[32:47]
    v_mfma_f32_32x32x16_bf16 v[48:63], a[148:151], v[192:195], v[48:63]
    v_mfma_f32_32x32x16_bf16 v[64:79], a[148:151], v[196:199], v[64:79]
    s_waitcnt vmcnt(9)
    v_mfma_f32_32x32x16_bf16 v[16:31], a[176:179], v[200:203], v[16:31]
    buffer_load_dwordx4 v[208:211], v236, s[44:47], s75 offen sc1
    buffer_load_dwordx4 v[212:215], v237, s[44:47], s75 offen sc1
    s_waitcnt vmcnt(10)
    v_mfma_f32_32x32x16_bf16 v[32:47], a[176:179], v[204:207], v[32:47]
    v_mfma_f32_32x32x16_bf16 v[48:63], a[180:183], v[200:203], v[48:63]
    v_mfma_f32_32x32x16_bf16 v[64:79], a[180:183], v[204:207], v[64:79]
    s_waitcnt vmcnt(9)
    v_mfma_f32_32x32x16_bf16 v[16:31], a[208:211], a[224:227], v[16:31]
    buffer_load_dwordx4 v[80:83], v236, s[44:47], s79 offen sc1
    buffer_load_dwordx4 v[84:87], v237, s[44:47], s79 offen sc1
    s_waitcnt vmcnt(10)
    v_mfma_f32_32x32x16_bf16 v[32:47], a[208:211], a[228:231], v[32:47]
    v_mfma_f32_32x32x16_bf16 v[48:63], a[212:215], a[224:227], v[48:63]
    v_mfma_f32_32x32x16_bf16 v[64:79], a[212:215], a[228:231], v[64:79]
    s_waitcnt vmcnt(9)
    v_mfma_f32_32x32x16_bf16 v[16:31], a[56:59], a[232:235], v[16:31]
    buffer_load_dwordx4 v[88:91], v236, s[44:47], s83 offen sc1
    buffer_load_dwordx4 v[92:95], v237, s[44:47], s83 offen sc1
    s_lshr_b32 s90, s94, 4
    s_lshl_b32 s91, s95, 1
    s_add_u32 s91, s91, s90
    s_lshl_b32 s91, s91, 12
    s_lshl_b32 s90, s97, 11
    s_add_u32 s91, s91, s90
    s_add_u32 s91, s91, 13762560
    v_and_b32 v6, 31, v0
    v_lshlrev_b32 v6, 6, v6
    buffer_load_dwordx2 v[4:5], v6, s[44:47], s91 offen sc1
    s_waitcnt vmcnt(11)
    v_mfma_f32_32x32x16_bf16 v[32:47], a[56:59], a[236:239], v[32:47]
    s_lshl_b32 s90, s94, 1
    s_add_u32 s90, s90, s53
    s_lshl_b32 s90, s90, 8
    s_add_u32 s90, s90, 12582912
    buffer_load_dwordx2 v[8:9], v247, s[44:47], s90 offen sc1
    v_mfma_f32_32x32x16_bf16 v[48:63], a[60:63], a[232:235], v[48:63]
    v_mfma_f32_32x32x16_bf16 v[64:79], a[60:63], a[236:239], v[64:79]
    s_waitcnt vmcnt(11)
    v_mfma_f32_32x32x16_bf16 v[16:31], a[88:91], a[240:243], v[16:31]
    s_waitcnt vmcnt(10)
    v_mfma_f32_32x32x16_bf16 v[32:47], a[88:91], a[244:247], v[32:47]
    v_mfma_f32_32x32x16_bf16 v[48:63], a[92:95], a[240:243], v[48:63]
    v_mfma_f32_32x32x16_bf16 v[64:79], a[92:95], a[244:247], v[64:79]
    s_waitcnt vmcnt(9)
    v_mfma_f32_32x32x16_bf16 v[16:31], a[120:123], a[248:251], v[16:31]
    s_waitcnt vmcnt(8)
    v_mfma_f32_32x32x16_bf16 v[32:47], a[120:123], a[252:255], v[32:47]
    v_mfma_f32_32x32x16_bf16 v[48:63], a[124:127], a[248:251], v[48:63]
    v_mfma_f32_32x32x16_bf16 v[64:79], a[124:127], a[252:255], v[64:79]
    s_waitcnt vmcnt(7)
    v_mfma_f32_32x32x16_bf16 v[16:31], a[152:155], v[208:211], v[16:31]
    s_waitcnt vmcnt(6)
    v_mfma_f32_32x32x16_bf16 v[32:47], a[152:155], v[212:215], v[32:47]
    v_mfma_f32_32x32x16_bf16 v[48:63], a[156:159], v[208:211], v[48:63]
    v_mfma_f32_32x32x16_bf16 v[64:79], a[156:159], v[212:215], v[64:79]
    s_waitcnt vmcnt(5)
    v_mfma_f32_32x32x16_bf16 v[16:31], a[184:187], v[80:83], v[16:31]
    s_waitcnt vmcnt(4)
    v_mfma_f32_32x32x16_bf16 v[32:47], a[184:187], v[84:87], v[32:47]
    v_mfma_f32_32x32x16_bf16 v[48:63], a[188:191], v[80:83], v[48:63]
    v_mfma_f32_32x32x16_bf16 v[64:79], a[188:191], v[84:87], v[64:79]
    s_waitcnt vmcnt(3)
    v_mfma_f32_32x32x16_bf16 v[16:31], a[216:219], v[88:91], v[16:31]
    s_waitcnt vmcnt(1)
    v_cmp_ne_u64 vcc, v[2:3], v[4:5]
    s_cbranch_vccz L_ok_f3_9
    s_mov_b32 s1, 0
L_spin_f3_10:
    s_sleep 1
    buffer_load_dwordx2 v[4:5], v6, s[44:47], s91 offen sc1
    s_waitcnt vmcnt(0)
    v_cmp_ne_u64 vcc, v[2:3], v[4:5]
    s_cbranch_vccz L_ok_f3_9
    s_add_u32 s1, s1, 1
    s_cmp_lt_u32 s1, 0x10000
    s_cbranch_scc1 L_spin_f3_10
L_ok_f3_9:
    v_mfma_f32_32x32x16_bf16 v[32:47], a[216:219], v[92:95], v[32:47]
    s_add_u32 m0, s96, 2048
    s_nop 0
    buffer_load_dwordx4 v239, s[44:47], 0 offen sc1 lds
    v_add_u32 v10, 64512, v239
    buffer_load_dwordx4 v10, s[44:47], 0 offen offset:1024 sc1 lds
    v_mfma_f32_32x32x16_bf16 v[48:63], a[220:223], v[88:91], v[48:63]
    v_mfma_f32_32x32x16_bf16 v[64:79], a[220:223], v[92:95], v[64:79]
    s_waitcnt vmcnt(0)
    ds_read_b64 v[80:81], v240 offset:0
    ds_read_b64 v[82:83], v240 offset:16
    ds_read_b64 v[84:85], v240 offset:32
    ds_read_b64 v[86:87], v240 offset:48
    ds_read_b64_tr_b16 v[88:89], v241 offset:0
    ds_read_b64_tr_b16 v[90:91], v241 offset:512
    ds_read_b64_tr_b16 v[92:93], v241 offset:1024
    ds_read_b64_tr_b16 v[94:95], v241 offset:1536
    s_xor_b32 s3, s4, 1
    s_lshl_b32 s3, s3, 12
    s_add_u32 s3, s3, 107008
    v_add_u32 v242, s3, v1
    ds_write_b128 v242, v[32:35] offset:0
    ds_write_b128 v242, v[36:39] offset:1024
    ds_write_b128 v242, v[40:43] offset:2048
    ds_write_b128 v242, v[44:47] offset:3072
    s_xor_b32 s3, s4, 2
    s_lshl_b32 s3, s3, 12
    s_add_u32 s3, s3, 123392
    v_add_u32 v242, s3, v1
    ds_write_b128 v242, v[48:51] offset:0
    ds_write_b128 v242, v[52:55] offset:1024
    ds_write_b128 v242, v[56:59] offset:2048
    ds_write_b128 v242, v[60:63] offset:3072
    s_xor_b32 s3, s4, 3
    s_lshl_b32 s3, s3, 12
    s_add_u32 s3, s3, 139776
    v_add_u32 v242, s3, v1
    ds_write_b128 v242, v[64:67] offset:0
    ds_write_b128 v242, v[68:71] offset:1024
    ds_write_b128 v242, v[72:75] offset:2048
    ds_write_b128 v242, v[76:79] offset:3072
    s_waitcnt lgkmcnt(15)
    v_lshlrev_b32 v96, 16, v80
    v_and_b32 v97, 0xffff0000, v80
    s_waitcnt lgkmcnt(15)
    v_lshlrev_b32 v80, 16, v88
    v_and_b32 v88, 0xffff0000, v88
    v_mul_f32 v96, v96, v80
    v_mul_f32 v97, v97, v88
    v_mul_f32 v96, v96, v8
    v_mul_f32 v97, v97, v8
    v_lshlrev_b32 v98, 16, v81
    v_and_b32 v99, 0xffff0000, v81
    v_lshlrev_b32 v81, 16, v89
    v_and_b32 v89, 0xffff0000, v89
    v_mul_f32 v98, v98, v81
    v_mul_f32 v99, v99, v89
    v_mul_f32 v98, v98, v8
    v_mul_f32 v99, v99, v8
    v_lshlrev_b32 v100, 16, v82
    v_and_b32 v101, 0xffff0000, v82
    s_waitcnt lgkmcnt(14)
    v_lshlrev_b32 v82, 16, v90
    v_and_b32 v90, 0xffff0000, v90
    v_mul_f32 v100, v100, v82
    v_mul_f32 v101, v101, v90
    v_mul_f32 v100, v100, v8
    v_mul_f32 v101, v101, v8
    v_lshlrev_b32 v102, 16, v83
    v_and_b32 v103, 0xffff0000, v83
    v_lshlrev_b32 v83, 16, v91
    v_and_b32 v91, 0xffff0000, v91
    v_mul_f32 v102, v102, v83
    v_mul_f32 v103, v103, v91
    v_mul_f32 v102, v102, v8
    v_mul_f32 v103, v103, v8
    v_lshlrev_b32 v104, 16, v84
    v_and_b32 v105, 0xffff0000, v84
    s_waitcnt lgkmcnt(13)
    v_lshlrev_b32 v84, 16, v92
    v_and_b32 v92, 0xffff0000, v92
    v_mul_f32 v104, v104, v84
    v_mul_f32 v105, v105, v92
    v_mul_f32 v104, v104, v8
    v_mul_f32 v105, v105, v8
    v_lshlrev_b32 v106, 16, v85
    v_and_b32 v107, 0xffff0000, v85
    v_lshlrev_b32 v85, 16, v93
    v_and_b32 v93, 0xffff0000, v93
    v_mul_f32 v106, v106, v85
    v_mul_f32 v107, v107, v93
    v_mul_f32 v106, v106, v8
    v_mul_f32 v107, v107, v8
    v_lshlrev_b32 v108, 16, v86
    v_and_b32 v109, 0xffff0000, v86
    s_waitcnt lgkmcnt(12)
    v_lshlrev_b32 v86, 16, v94
    v_and_b32 v94, 0xffff0000, v94
    v_mul_f32 v108, v108, v86
    v_mul_f32 v109, v109, v94
    v_mul_f32 v108, v108, v8
    v_mul_f32 v109, v109, v8
    v_lshlrev_b32 v110, 16, v87
    v_and_b32 v111, 0xffff0000, v87
    v_lshlrev_b32 v87, 16, v95
    v_and_b32 v95, 0xffff0000, v95
    v_mul_f32 v110, v110, v87
    v_mul_f32 v111, v111, v95
    v_mul_f32 v110, v110, v8
    v_mul_f32 v111, v111, v8
    s_waitcnt lgkmcnt(0)
    s_barrier
    ds_read_b128 v[112:115], v243 offset:0
    ds_read_b128 v[116:119], v243 offset:1024
    ds_read_b128 v[120:123], v243 offset:2048
    ds_read_b128 v[124:127], v243 offset:3072
    ds_read_b128 v[128:131], v243 offset:16384
    ds_read_b128 v[132:135], v243 offset:17408
    ds_read_b128 v[136:139], v243 offset:18432
    ds_read_b128 v[140:143], v243 offset:19456
    ds_read_b128 v[144:147], v243 offset:32768
    ds_read_b128 v[148:151], v243 offset:33792
    ds_read_b128 v[152:155], v243 offset:34816
    ds_read_b128 v[156:159], v243 offset:35840
    s_waitcnt lgkmcnt(11)
    v_pk_add_f32 v[16:17], v[16:17], v[112:113]
    v_pk_add_f32 v[18:19], v[18:19], v[114:115]
    s_waitcnt lgkmcnt(10)
    v_pk_add_f32 v[20:21], v[20:21], v[116:117]
    v_pk_add_f32 v[22:23], v[22:23], v[118:119]
    s_waitcnt lgkmcnt(9)
    v_pk_add_f32 v[24:25], v[24:25], v[120:121]
    v_pk_add_f32 v[26:27], v[26:27], v[122:123]
    s_waitcnt lgkmcnt(8)
    v_pk_add_f32 v[28:29], v[28:29], v[124:125]
    v_pk_add_f32 v[30:31], v[30:31], v[126:127]
    s_waitcnt lgkmcnt(7)
    v_pk_add_f32 v[16:17], v[16:17], v[128:129]
    v_pk_add_f32 v[18:19], v[18:19], v[130:131]
    s_waitcnt lgkmcnt(6)
    v_pk_add_f32 v[20:21], v[20:21], v[132:133]
    v_pk_add_f32 v[22:23], v[22:23], v[134:135]
    s_waitcnt lgkmcnt(5)
    v_pk_add_f32 v[24:25], v[24:25], v[136:137]
    v_pk_add_f32 v[26:27], v[26:27], v[138:139]
    s_waitcnt lgkmcnt(4)
    v_pk_add_f32 v[28:29], v[28:29], v[140:141]
    v_pk_add_f32 v[30:31], v[30:31], v[142:143]
    s_waitcnt lgkmcnt(3)
    v_pk_add_f32 v[16:17], v[16:17], v[144:145]
    v_pk_add_f32 v[18:19], v[18:19], v[146:147]
    s_waitcnt lgkmcnt(2)
    v_pk_add_f32 v[20:21], v[20:21], v[148:149]
    v_pk_add_f32 v[22:23], v[22:23], v[150:151]
    s_waitcnt lgkmcnt(1)
    v_pk_add_f32 v[24:25], v[24:25], v[152:153]
    v_pk_add_f32 v[26:27], v[26:27], v[154:155]
    s_waitcnt lgkmcnt(0)
    v_pk_add_f32 v[28:29], v[28:29], v[156:157]
    v_pk_add_f32 v[30:31], v[30:31], v[158:159]
    v_fmac_f32 v96, v16, v9
    v_fmac_f32 v97, v17, v9
    v_fmac_f32 v98, v18, v9
    v_fmac_f32 v99, v19, v9
    v_fmac_f32 v100, v20, v9
    v_fmac_f32 v101, v21, v9
    v_fmac_f32 v102, v22, v9
    v_fmac_f32 v103, v23, v9
    v_fmac_f32 v104, v24, v9
    v_fmac_f32 v105, v25, v9
    v_fmac_f32 v106, v26, v9
    v_fmac_f32 v107, v27, v9
    v_fmac_f32 v108, v28, v9
    v_fmac_f32 v109, v29, v9
    v_fmac_f32 v110, v30, v9
    v_fmac_f32 v111, v31, v9
    v_cvt_pk_bf16_f32 v16, v96, v97
    v_cvt_pk_bf16_f32 v17, v98, v99
    v_cvt_pk_bf16_f32 v18, v100, v101
    v_cvt_pk_bf16_f32 v19, v102, v103
    v_cvt_pk_bf16_f32 v20, v104, v105
    v_cvt_pk_bf16_f32 v21, v106, v107
    v_cvt_pk_bf16_f32 v22, v108, v109
    v_cvt_pk_bf16_f32 v23, v110, v111
    ds_write_b64 v244, v[16:17] offset:0
    ds_write_b64 v244, v[18:19] offset:16
    ds_write_b64 v244, v[20:21] offset:32
    ds_write_b64 v244, v[22:23] offset:48
    ds_read_b128 v[112:115], v245
    ds_read_b128 v[116:119], v245 offset:1280
    s_mov_b32 s3, 16384
    s_waitcnt lgkmcnt(1)
    buffer_store_dwordx4 v[112:115], v246, s[40:43], 0 offen sc1
    s_waitcnt lgkmcnt(0)
    buffer_store_dwordx4 v[116:119], v246, s[40:43], s3 offen sc1
L_end:
    s_endpgm
.section .rodata,"a"
.p2align 6
.amdhsa_kernel gated_mix__ssm_conv_h3__glu_gated_reglu__prompt_kernel
  .amdhsa_next_free_vgpr 512
  .amdhsa_next_free_sgpr 102
  .amdhsa_accum_offset 256
  .amdhsa_group_segment_fixed_size 0
  .amdhsa_kernarg_size 112
  .amdhsa_user_sgpr_count 2
  .amdhsa_user_sgpr_kernarg_segment_ptr 1
  .amdhsa_system_sgpr_workgroup_id_x 1
  .amdhsa_float_denorm_mode_32 3
.end_amdhsa_kernel
```
